```python
import torch

def _softmax(x, axis=-1):
    return torch.softmax(x, dim=axis)
def _gelu(x):
    return torch.nn.functional.gelu(x, approximate="tanh")
def _silu(x):
    return torch.nn.functional.silu(x)
def _sigmoid(x):
    return torch.sigmoid(x)
def _layernorm(x, axis=-1, eps=1e-5):
    m = x.mean(dim=axis, keepdim=True)
    v = x.var(dim=axis, keepdim=True, unbiased=False)
    return (x - m) / torch.sqrt(v + eps)
def _scatter_add(tgt, idx, src, axis=0):
    return tgt.clone().index_add_(axis, idx, src)
def _segment_sum(src, seg, n):
    out = torch.zeros((n,) + src.shape[1:], dtype=src.dtype)
    return out.index_add_(0, seg, src)
def _pad(x, pw):
    flat = tuple(v for pair in reversed(pw) for v in pair)
    return torch.nn.functional.pad(x, flat)

kernel_name = 'recurrent_scan__compressed_kv_cla__geglu_ffn__decode'

def setup_inputs():

    _w = (lambda a: (lambda t: t.to(torch.bfloat16) if t.is_floating_point() else t)(torch.as_tensor(a)))
    def _A_setup():
        B, H, Sq, Sk, D, M = 2, 16, 1, 4096, 256, 448
        Dc = 4 * D
        return {
            "x": _w((lambda *s: torch.randn(*s, dtype=torch.bfloat16) * 0.05)(B, Sq, M)),
            "c_kv": _w((lambda *s: torch.randn(*s, dtype=torch.bfloat16) * 0.8)(B, Sk, Dc)),
            "w_q": _w((lambda *s: torch.randn(*s, dtype=torch.bfloat16) * 1.6)(M, H, D) * (M ** -0.5)),
            "w_uk": _w((lambda *s: torch.randn(*s, dtype=torch.bfloat16) * 1.6)(Dc, H, D) * (Dc ** -0.5)),
            "w_uv": _w((lambda *s: torch.randn(*s, dtype=torch.bfloat16) * 0.8)(Dc, H, D) * (Dc ** -0.5)),
            "w_o": _w((lambda *s: torch.randn(*s, dtype=torch.bfloat16) * 0.8)(H, D, M) * ((H * D) ** -0.5)),
        }
    _A_in = _A_setup()

    def _B_setup():
        B, S, D, F = 2, 1, 448, 1792
        return {
            "x": _w((lambda *s: torch.randn(*s, dtype=torch.bfloat16) * 0.05)(B, S, D)),
            "w_gate": _w((lambda *s: torch.randn(*s, dtype=torch.bfloat16) * 0.2)(D, F)),
            "w_up": _w((lambda *s: torch.randn(*s, dtype=torch.bfloat16) * 0.2)(D, F)),
            "w_down": _w((lambda *s: torch.randn(*s, dtype=torch.bfloat16) * 0.2)(F, D)),
        }
    _B_in = _B_setup()

    return {
        "A_x": _A_in["x"],
        "A_c_kv": _A_in["c_kv"],
        "A_w_q": _A_in["w_q"],
        "A_w_uk": _A_in["w_uk"],
        "A_w_uv": _A_in["w_uv"],
        "A_w_o": _A_in["w_o"],
        "B_x": _B_in["x"],
        "B_w_gate": _B_in["w_gate"],
        "B_w_up": _B_in["w_up"],
        "B_w_down": _B_in["w_down"],
    }

def reference(A_x, A_c_kv, A_w_q, A_w_uk, A_w_uv, A_w_o, B_x, B_w_gate, B_w_up, B_w_down):
    def _A_ref(x, c_kv, w_q, w_uk, w_uv, w_o):
        B, Sq, M = x.shape[0], x.shape[1], x.shape[2]
        Sk = c_kv.shape[1]
        H, D = w_q.shape[1], w_q.shape[2]
        q = torch.einsum("bqm,mhd->bhqd", x, w_q)
        k = torch.einsum("bkc,chd->bhkd", c_kv, w_uk)
        v = torch.einsum("bkc,chd->bhkd", c_kv, w_uv)
        scores = torch.einsum("bhqd,bhkd->bhqk", q, k) * (D ** -0.5)
        off = Sk - Sq
        qi = torch.arange(Sq)[:, None]
        kj = torch.arange(Sk)[None, :]
        cmask = kj <= (qi + off)
        scores = torch.where(cmask[None, None], scores, -1e9)
        p = _softmax(scores, axis=-1)
        ctx = torch.einsum("bhqk,bhkd->bhqd", p, v)
        return torch.einsum("bhqd,hdm->bqm", ctx, w_o)

    def _B_ref(x, w_gate, w_up, w_down):
        return (_gelu(x @ w_gate) * (x @ w_up)) @ w_down

    x = A_x
    xn = _layernorm(x, axis=-1)
    s = _A_ref(xn, A_c_kv, A_w_q, A_w_uk, A_w_uv, A_w_o)
    g = _silu(_B_ref(xn, B_w_gate, B_w_up, B_w_down))
    return x + s * g
```

```asm
; @launch grid=(256,1,1) block=(320,1,1) lds=163840
.amdgcn_target "amdgcn-amd-amdhsa--gfx950"
.text
.globl recurrent_scan__compressed_kv_cla__geglu_ffn__decode_kernel
.p2align 12
.p2align 8
.type recurrent_scan__compressed_kv_cla__geglu_ffn__decode_kernel,@function
recurrent_scan__compressed_kv_cla__geglu_ffn__decode_kernel:
    s_load_dwordx16 s[4:19], s[0:1], 0
    s_load_dwordx8 s[20:27], s[0:1], 64
    s_load_dwordx2 s[28:29], s[0:1], 96
    s_cmp_ge_u32 s2, 256
    s_cbranch_scc1 L_end
    s_getpc_b64 s[56:57]
L_pc:
    v_lshrrev_b32 v8, 6, v0
    s_lshr_b32 s31, s2, 3
    s_mul_i32 s51, s31, 640
    v_lshl_add_u32 v9, v8, 7, s51
    v_min_u32 v9, L_codeend-L_pc-4, v9
    global_load_dword v250, v9, s[56:57]
    v_and_b32 v1, 63, v0
    v_readfirstlane_b32 s3, v8
    s_and_b32 s30, s2, 7
    s_and_b32 s31, s31, 15
    s_and_b32 s46, s2, 127
    s_lshr_b32 s51, s31, 3
    s_lshl_b32 s32, s30, 1
    s_add_u32 s32, s32, s51
    s_and_b32 s36, s31, 3
    s_bfe_u32 s37, s31, 0x10002
    s_mov_b32 s50, 0x40000
    v_lshrrev_b32 v3, 4, v1
    v_mov_b32 v6, 161536
    v_lshlrev_b32 v7, 4, v1
    v_and_b32 v14, 3, v1
    v_lshlrev_b32 v14, 2, v14
    v_add_u32 v14, 161552, v14
    s_cmp_eq_u32 s3, 0
    s_cbranch_scc1 L_loader
    s_sub_u32 s48, s3, 1
    s_lshl_b32 s51, s48, 2
    s_add_u32 s51, s51, 161552
    v_mov_b32 v5, s51
    v_mov_b32 v8, 0
    ds_write_b32 v5, v8
    v_lshrrev_b32 v9, 5, v1
    v_mul_u32_u24 v9, 896, v9
    v_and_b32 v10, 31, v1
    v_lshl_add_u32 v10, v10, 5, v9
    s_and_b32 s100, s32, 7
    s_lshr_b32 s33, s30, 2
    s_cmp_ge_u32 s2, 128
    s_waitcnt lgkmcnt(0)
    s_load_dword s55, s[28:29], 0
    s_cbranch_scc0 L_g2bar
    global_load_ushort v24, v9, s[4:5]
    s_mov_b32 exec_lo, 0xfffffff
    s_mov_b32 exec_hi, 0xfffffff
    global_load_dwordx4 v[16:19], v10, s[4:5]
    global_load_dwordx4 v[20:23], v10, s[4:5] offset:16
    s_mov_b64 exec, -1
    s_barrier
    s_branch L_comp1
L_g2bar:
    s_barrier
    s_branch L_comp2
L_loader:
    s_setprio 3
    v_mov_b32 v19, 0
    ds_write_b32 v6, v19
    s_mov_b32 s43, 0x20000
    s_cmp_lt_u32 s2, 128
    s_cbranch_scc1 L_loader2
    v_lshrrev_b32 v8, 5, v1
    v_and_b32 v9, 31, v1
    v_lshlrev_b32 v9, 4, v9
    v_lshl_add_u32 v20, v8, 13, v9
    v_lshlrev_b32 v8, 5, v8
    v_xor_b32 v28, v8, v20
    v_xor_b32 v29, 64, v28
    v_xor_b32 v30, 128, v28
    v_xor_b32 v31, 192, v28
    s_and_b32 s53, s31, 7
    s_xor_b32 s51, s32, 1
    s_lshl_b32 s51, s51, 9
    s_lshl_b32 s44, s53, 19
    s_add_u32 s44, s44, s51
    s_mov_b32 m0, 94208
    v_mov_b32 v18, -40
    s_waitcnt lgkmcnt(0)
    s_mov_b32 s40, s8
    s_mov_b32 s41, s9
    s_mov_b32 s42, 3670016
    s_load_dword s55, s[28:29], 0
    s_barrier
    s_mov_b32 s45, 8
L_ld_1:
    buffer_load_dwordx4 v28, s[40:43], s44 offen nt lds
    s_add_u32 m0, m0, 1024
    s_add_u32 s44, s44, 16384
    buffer_load_dwordx4 v29, s[40:43], s44 offen nt lds
    s_add_u32 m0, m0, 1024
    s_add_u32 s44, s44, 16384
    buffer_load_dwordx4 v30, s[40:43], s44 offen nt lds
    s_add_u32 m0, m0, 1024
    s_add_u32 s44, s44, 16384
    buffer_load_dwordx4 v31, s[40:43], s44 offen nt lds
    s_add_u32 m0, m0, 1024
    s_add_u32 s44, s44, 16384
    v_add_u32 v18, 4, v18
    v_max_i32 v19, v19, v18
    s_waitcnt vmcnt(40)
    ds_write_b32 v6, v19
    s_sub_u32 s45, s45, 1
    s_cmp_lg_u32 s45, 0
    s_cbranch_scc1 L_ld_1
    v_xor_b32 v21, 32, v20
    v_xor_b32 v22, 64, v20
    v_xor_b32 v23, 96, v20
    v_xor_b32 v24, 128, v20
    v_xor_b32 v25, 160, v20
    v_xor_b32 v26, 192, v20
    v_xor_b32 v27, 224, v20
    s_lshl_b32 s54, s53, 20
    s_lshl_b32 s51, s32, 9
    s_add_u32 s54, s54, s51
    s_mov_b32 s44, s54
    s_mov_b32 m0, 0
    s_mov_b32 s40, s10
    s_mov_b32 s41, s11
    s_mov_b32 s42, 8388608
    s_mov_b32 s45, 4
L_ld_2:
    buffer_load_dwordx4 v20, s[40:43], s44 offen nt lds
    s_add_u32 m0, m0, 1024
    s_add_u32 s44, s44, 16384
    buffer_load_dwordx4 v20, s[40:43], s44 offen nt lds
    s_add_u32 m0, m0, 1024
    s_add_u32 s44, s44, 16384
    buffer_load_dwordx4 v21, s[40:43], s44 offen nt lds
    s_add_u32 m0, m0, 1024
    s_add_u32 s44, s44, 16384
    buffer_load_dwordx4 v21, s[40:43], s44 offen nt lds
    s_add_u32 m0, m0, 1024
    s_add_u32 s44, s44, 16384
    v_add_u32 v18, 4, v18
    v_max_i32 v19, v19, v18
    s_waitcnt vmcnt(40)
    ds_write_b32 v6, v19
    buffer_load_dwordx4 v22, s[40:43], s44 offen nt lds
    s_add_u32 m0, m0, 1024
    s_add_u32 s44, s44, 16384
    buffer_load_dwordx4 v22, s[40:43], s44 offen nt lds
    s_add_u32 m0, m0, 1024
    s_add_u32 s44, s44, 16384
    buffer_load_dwordx4 v23, s[40:43], s44 offen nt lds
    s_add_u32 m0, m0, 1024
    s_add_u32 s44, s44, 16384
    buffer_load_dwordx4 v23, s[40:43], s44 offen nt lds
    s_add_u32 m0, m0, 1024
    s_add_u32 s44, s44, 16384
    v_add_u32 v18, 4, v18
    v_max_i32 v19, v19, v18
    s_waitcnt vmcnt(40)
    ds_write_b32 v6, v19
    buffer_load_dwordx4 v24, s[40:43], s44 offen nt lds
    s_add_u32 m0, m0, 1024
    s_add_u32 s44, s44, 16384
    buffer_load_dwordx4 v24, s[40:43], s44 offen nt lds
    s_add_u32 m0, m0, 1024
    s_add_u32 s44, s44, 16384
    buffer_load_dwordx4 v25, s[40:43], s44 offen nt lds
    s_add_u32 m0, m0, 1024
    s_add_u32 s44, s44, 16384
    buffer_load_dwordx4 v25, s[40:43], s44 offen nt lds
    s_add_u32 m0, m0, 1024
    s_add_u32 s44, s44, 16384
    v_add_u32 v18, 4, v18
    v_max_i32 v19, v19, v18
    s_waitcnt vmcnt(40)
    ds_write_b32 v6, v19
    buffer_load_dwordx4 v26, s[40:43], s44 offen nt lds
    s_add_u32 m0, m0, 1024
    s_add_u32 s44, s44, 16384
    buffer_load_dwordx4 v26, s[40:43], s44 offen nt lds
    s_add_u32 m0, m0, 1024
    s_add_u32 s44, s44, 16384
    buffer_load_dwordx4 v27, s[40:43], s44 offen nt lds
    s_add_u32 m0, m0, 1024
    s_add_u32 s44, s44, 16384
    buffer_load_dwordx4 v27, s[40:43], s44 offen nt lds
    s_add_u32 m0, m0, 1024
    s_add_u32 s44, s44, 16384
    v_add_u32 v18, 4, v18
    v_max_i32 v19, v19, v18
    s_waitcnt vmcnt(40)
    ds_write_b32 v6, v19
    s_sub_u32 s45, s45, 1
    s_cmp_lg_u32 s45, 0
    s_cbranch_scc1 L_ld_2
    s_branch L_loader1b
L_loader2:
    s_waitcnt lgkmcnt(0)
    s_load_dword s55, s[28:29], 0
    s_barrier
    s_branch L_loader2b
L_comp1:
    v_and_b32 v2, 15, v1
    v_lshrrev_b32 v26, 2, v1
    v_and_b32 v27, 3, v1
    v_lshlrev_b32 v27, 3, v27
    s_mov_b32 s39, 0xfff
    v_and_b32 v8, 7, v26
    v_lshl_add_u32 v9, v26, 9, v27
    v_add_u32 v9, 94208, v9
    s_lshl_b32 s51, s48, 2
    s_add_u32 s51, s51, 0
    v_xor_b32 v11, s51, v8
    v_lshl_add_u32 v84, v11, 5, v9
    s_lshl_b32 s51, s48, 2
    s_add_u32 s51, s51, 1
    v_xor_b32 v11, s51, v8
    v_lshl_add_u32 v85, v11, 5, v9
    s_lshl_b32 s51, s48, 2
    s_add_u32 s51, s51, 2
    v_xor_b32 v11, s51, v8
    v_lshl_add_u32 v86, v11, 5, v9
    s_lshl_b32 s51, s48, 2
    s_add_u32 s51, s51, 3
    v_xor_b32 v11, s51, v8
    v_lshl_add_u32 v87, v11, 5, v9
    v_bfe_u32 v28, v1, 2, 1
    v_mul_u32_u24 v31, 896, v28
    v_lshl_add_u32 v31, v3, 3, v31
    v_add_u32 v31, 159744, v31
    s_and_b32 s54, s31, 7
    s_lshl_b32 s51, s54, 7
    v_add_u32 v30, s51, v31
    s_xor_b32 s53, s100, 1
    s_lshl_b32 s51, s53, 18
    s_lshl_b32 s52, s33, 14
    s_add_u32 s51, s51, s52
    s_lshl_b32 s52, s48, 12
    s_add_u32 s51, s51, s52
    s_lshl_b32 s52, s54, 9
    s_add_u32 s51, s51, s52
    s_add_u32 s51, s51, 4096
    v_add_u32 v54, s51, v7
    v_add_u32 v55, 2224128, v54
    s_mov_b32 exec_lo, 0xffffffff
    s_mov_b32 exec_hi, 0x0
    global_load_dwordx4 v[244:247], v55, s[28:29] sc1
    s_mov_b64 exec, -1
    v_add_u32 v25, 159744, v10
    v_mov_b32 v48, 0
    v_mov_b32 v49, 0
    v_mov_b32 v50, 0
    v_mov_b32 v51, 0
    s_waitcnt vmcnt(1) lgkmcnt(0)
    s_add_u32 s58, s55, 1
    s_and_b32 s38, s58, 0xfff
    v_mov_b32 v4, s38
    v_lshlrev_b32 v24, 16, v24
    v_lshlrev_b32 v32, 16, v16
    v_and_b32 v33, 0xffff0000, v16
    v_lshlrev_b32 v34, 16, v17
    v_and_b32 v35, 0xffff0000, v17
    v_lshlrev_b32 v36, 16, v18
    v_and_b32 v37, 0xffff0000, v18
    v_lshlrev_b32 v38, 16, v19
    v_and_b32 v39, 0xffff0000, v19
    v_lshlrev_b32 v40, 16, v20
    v_and_b32 v41, 0xffff0000, v20
    v_lshlrev_b32 v42, 16, v21
    v_and_b32 v43, 0xffff0000, v21
    v_lshlrev_b32 v44, 16, v22
    v_and_b32 v45, 0xffff0000, v22
    v_lshlrev_b32 v46, 16, v23
    v_and_b32 v47, 0xffff0000, v23
    s_mov_b32 exec_lo, 0xfffffff
    s_mov_b32 exec_hi, 0xfffffff
    v_pk_add_f32 v[56:57], v[32:33], v[24:25] op_sel_hi:[1,0] neg_lo:[0,1] neg_hi:[0,1]
    v_pk_add_f32 v[52:53], v[34:35], v[24:25] op_sel_hi:[1,0] neg_lo:[0,1] neg_hi:[0,1]
    v_pk_add_f32 v[48:49], v[48:49], v[56:57]
    v_pk_fma_f32 v[50:51], v[56:57], v[56:57], v[50:51]
    v_pk_add_f32 v[56:57], v[36:37], v[24:25] op_sel_hi:[1,0] neg_lo:[0,1] neg_hi:[0,1]
    v_pk_add_f32 v[48:49], v[48:49], v[52:53]
    v_pk_fma_f32 v[50:51], v[52:53], v[52:53], v[50:51]
    v_pk_add_f32 v[52:53], v[38:39], v[24:25] op_sel_hi:[1,0] neg_lo:[0,1] neg_hi:[0,1]
    v_pk_add_f32 v[48:49], v[48:49], v[56:57]
    v_pk_fma_f32 v[50:51], v[56:57], v[56:57], v[50:51]
    v_pk_add_f32 v[56:57], v[40:41], v[24:25] op_sel_hi:[1,0] neg_lo:[0,1] neg_hi:[0,1]
    v_pk_add_f32 v[48:49], v[48:49], v[52:53]
    v_pk_fma_f32 v[50:51], v[52:53], v[52:53], v[50:51]
    v_pk_add_f32 v[52:53], v[42:43], v[24:25] op_sel_hi:[1,0] neg_lo:[0,1] neg_hi:[0,1]
    v_pk_add_f32 v[48:49], v[48:49], v[56:57]
    v_pk_fma_f32 v[50:51], v[56:57], v[56:57], v[50:51]
    v_pk_add_f32 v[56:57], v[44:45], v[24:25] op_sel_hi:[1,0] neg_lo:[0,1] neg_hi:[0,1]
    v_pk_add_f32 v[48:49], v[48:49], v[52:53]
    v_pk_fma_f32 v[50:51], v[52:53], v[52:53], v[50:51]
    v_pk_add_f32 v[52:53], v[46:47], v[24:25] op_sel_hi:[1,0] neg_lo:[0,1] neg_hi:[0,1]
    v_pk_add_f32 v[48:49], v[48:49], v[56:57]
    v_pk_fma_f32 v[50:51], v[56:57], v[56:57], v[50:51]
    v_pk_add_f32 v[48:49], v[48:49], v[52:53]
    v_pk_fma_f32 v[50:51], v[52:53], v[52:53], v[50:51]
    s_mov_b64 exec, -1
    v_add_f32 v48, v48, v49
    v_add_f32 v50, v50, v51
    s_nop 0
    v_add_f32_dpp v48, v48, v48 row_ror:8 row_mask:0xf bank_mask:0xf
    v_add_f32_dpp v50, v50, v50 row_ror:8 row_mask:0xf bank_mask:0xf
    s_nop 0
    v_add_f32_dpp v48, v48, v48 row_ror:4 row_mask:0xf bank_mask:0xf
    v_add_f32_dpp v50, v50, v50 row_ror:4 row_mask:0xf bank_mask:0xf
    s_nop 0
    v_add_f32_dpp v48, v48, v48 row_ror:2 row_mask:0xf bank_mask:0xf
    v_add_f32_dpp v50, v50, v50 row_ror:2 row_mask:0xf bank_mask:0xf
    s_nop 0
    v_add_f32_dpp v48, v48, v48 row_ror:1 row_mask:0xf bank_mask:0xf
    v_add_f32_dpp v50, v50, v50 row_ror:1 row_mask:0xf bank_mask:0xf
    v_mov_b32 v49, v48
    v_mov_b32 v51, v50
    s_nop 0
    v_permlane16_swap_b32 v48, v49
    v_permlane16_swap_b32 v50, v51
    v_add_f32 v48, v48, v49
    v_add_f32 v50, v50, v51
    v_mul_f32 v48, 0x3b124925, v48
    v_mul_f32 v50, 0x3b124925, v50
    v_fma_f32 v50, -v48, v48, v50
    v_add_f32 v48, v48, v24
    v_max_f32 v50, 0, v50
    v_cvt_pk_bf16_f32 v48, v48, v48
    v_and_b32 v48, 0xffff0000, v48
    v_cvt_pk_bf16_f32 v50, v50, v50
    v_and_b32 v50, 0xffff0000, v50
    v_add_f32 v50, 0x3727c5ac, v50
    v_cvt_pk_bf16_f32 v50, v50, v50
    v_and_b32 v50, 0xffff0000, v50
    v_sqrt_f32 v50, v50
    v_pk_add_f32 v[32:33], v[32:33], v[48:49] op_sel_hi:[1,0] neg_lo:[0,1] neg_hi:[0,1]
    v_pk_add_f32 v[34:35], v[34:35], v[48:49] op_sel_hi:[1,0] neg_lo:[0,1] neg_hi:[0,1]
    v_pk_add_f32 v[36:37], v[36:37], v[48:49] op_sel_hi:[1,0] neg_lo:[0,1] neg_hi:[0,1]
    v_pk_add_f32 v[38:39], v[38:39], v[48:49] op_sel_hi:[1,0] neg_lo:[0,1] neg_hi:[0,1]
    v_pk_add_f32 v[40:41], v[40:41], v[48:49] op_sel_hi:[1,0] neg_lo:[0,1] neg_hi:[0,1]
    v_pk_add_f32 v[42:43], v[42:43], v[48:49] op_sel_hi:[1,0] neg_lo:[0,1] neg_hi:[0,1]
    v_pk_add_f32 v[44:45], v[44:45], v[48:49] op_sel_hi:[1,0] neg_lo:[0,1] neg_hi:[0,1]
    v_pk_add_f32 v[46:47], v[46:47], v[48:49] op_sel_hi:[1,0] neg_lo:[0,1] neg_hi:[0,1]
    v_cvt_pk_bf16_f32 v50, v50, v50
    v_and_b32 v50, 0xffff0000, v50
    v_rcp_f32 v50, v50
    v_cvt_pk_bf16_f32 v16, v32, v33
    v_cvt_pk_bf16_f32 v17, v34, v35
    v_cvt_pk_bf16_f32 v18, v36, v37
    v_cvt_pk_bf16_f32 v19, v38, v39
    v_cvt_pk_bf16_f32 v20, v40, v41
    v_cvt_pk_bf16_f32 v21, v42, v43
    v_cvt_pk_bf16_f32 v22, v44, v45
    v_cvt_pk_bf16_f32 v23, v46, v47
    v_lshlrev_b32 v32, 16, v16
    v_and_b32 v33, 0xffff0000, v16
    v_lshlrev_b32 v34, 16, v17
    v_and_b32 v35, 0xffff0000, v17
    v_lshlrev_b32 v36, 16, v18
    v_and_b32 v37, 0xffff0000, v18
    v_lshlrev_b32 v38, 16, v19
    v_and_b32 v39, 0xffff0000, v19
    v_lshlrev_b32 v40, 16, v20
    v_and_b32 v41, 0xffff0000, v20
    v_lshlrev_b32 v42, 16, v21
    v_and_b32 v43, 0xffff0000, v21
    v_lshlrev_b32 v44, 16, v22
    v_and_b32 v45, 0xffff0000, v22
    v_lshlrev_b32 v46, 16, v23
    v_and_b32 v47, 0xffff0000, v23
    v_pk_mul_f32 v[32:33], v[32:33], v[50:51] op_sel_hi:[1,0]
    v_pk_mul_f32 v[34:35], v[34:35], v[50:51] op_sel_hi:[1,0]
    v_pk_mul_f32 v[36:37], v[36:37], v[50:51] op_sel_hi:[1,0]
    v_pk_mul_f32 v[38:39], v[38:39], v[50:51] op_sel_hi:[1,0]
    v_pk_mul_f32 v[40:41], v[40:41], v[50:51] op_sel_hi:[1,0]
    v_pk_mul_f32 v[42:43], v[42:43], v[50:51] op_sel_hi:[1,0]
    v_pk_mul_f32 v[44:45], v[44:45], v[50:51] op_sel_hi:[1,0]
    v_pk_mul_f32 v[46:47], v[46:47], v[50:51] op_sel_hi:[1,0]
    v_cvt_pk_bf16_f32 v16, v32, v33
    v_cvt_pk_bf16_f32 v17, v34, v35
    v_cvt_pk_bf16_f32 v18, v36, v37
    v_cvt_pk_bf16_f32 v19, v38, v39
    v_cvt_pk_bf16_f32 v20, v40, v41
    v_cvt_pk_bf16_f32 v21, v42, v43
    v_cvt_pk_bf16_f32 v22, v44, v45
    v_cvt_pk_bf16_f32 v23, v46, v47
    s_mov_b32 exec_lo, 0xfffffff
    s_mov_b32 exec_hi, 0xfffffff
    ds_write_b128 v25, v[16:19]
    ds_write_b128 v25, v[20:23] offset:16
    s_mov_b64 exec, -1
    s_cmp_eq_u32 s54, 7
    s_cbranch_scc1 L_nop1
    ds_read2_b64 v[64:67], v30 offset0:0 offset1:4
    ds_read2_b64 v[68:71], v30 offset0:8 offset1:12
L_wf_3:
    ds_read_b32 v8, v6 offset:0
    s_sub_u32 s50, s50, 1
    s_cbranch_scc1 L_end
    s_waitcnt lgkmcnt(0)
    v_cmp_gt_i32 vcc, 32, v8
    s_cbranch_vccnz L_wf_3
    ds_read_b64_tr_b16 v[96:97], v84 offset:0
    ds_read_b64_tr_b16 v[98:99], v84 offset:8192
    ds_read_b64_tr_b16 v[100:101], v85 offset:0
    ds_read_b64_tr_b16 v[102:103], v85 offset:8192
    ds_read_b64_tr_b16 v[104:105], v86 offset:0
    ds_read_b64_tr_b16 v[106:107], v86 offset:8192
    ds_read_b64_tr_b16 v[108:109], v87 offset:0
    ds_read_b64_tr_b16 v[110:111], v87 offset:8192
    ds_read_b64_tr_b16 v[112:113], v84 offset:16384
    ds_read_b64_tr_b16 v[114:115], v84 offset:24576
    ds_read_b64_tr_b16 v[116:117], v85 offset:16384
    ds_read_b64_tr_b16 v[118:119], v85 offset:24576
    ds_read_b64_tr_b16 v[120:121], v86 offset:16384
    ds_read_b64_tr_b16 v[122:123], v86 offset:24576
    ds_read_b64_tr_b16 v[124:125], v87 offset:16384
    ds_read_b64_tr_b16 v[126:127], v87 offset:24576
    s_waitcnt lgkmcnt(14)
    v_mfma_f32_16x16x32_bf16 v[32:35], v[64:67], v[96:99], 0
    s_waitcnt lgkmcnt(12)
    v_mfma_f32_16x16x32_bf16 v[36:39], v[64:67], v[100:103], 0
    s_waitcnt lgkmcnt(10)
    v_mfma_f32_16x16x32_bf16 v[40:43], v[64:67], v[104:107], 0
    s_waitcnt lgkmcnt(8)
    v_mfma_f32_16x16x32_bf16 v[44:47], v[64:67], v[108:111], 0
    s_waitcnt lgkmcnt(6)
    v_mfma_f32_16x16x32_bf16 v[32:35], v[68:71], v[112:115], v[32:35]
    s_waitcnt lgkmcnt(4)
    v_mfma_f32_16x16x32_bf16 v[36:39], v[68:71], v[116:119], v[36:39]
    s_waitcnt lgkmcnt(2)
    v_mfma_f32_16x16x32_bf16 v[40:43], v[68:71], v[120:123], v[40:43]
    s_waitcnt lgkmcnt(0)
    v_mfma_f32_16x16x32_bf16 v[44:47], v[68:71], v[124:127], v[44:47]
    s_nop 1
    v_bfi_b32 v48, s39, v4, v32
    s_nop 0
    v_bfi_b32 v49, s39, v4, v36
    s_nop 0
    v_bfi_b32 v50, s39, v4, v40
    s_nop 0
    v_bfi_b32 v51, s39, v4, v44
    s_mov_b32 exec_lo, 0xffffffff
    s_mov_b32 exec_hi, 0x0
    global_store_dwordx4 v55, v[48:51], s[28:29]
    s_mov_b64 exec, -1
L_nop1:
    s_xor_b32 s47, s46, 64
    s_cmp_lt_u32 s47, 98
    s_cselect_b32 s49, 32, 0
    s_lshl_b32 s51, s100, 18
    s_lshl_b32 s52, s33, 14
    s_add_u32 s51, s51, s52
    s_lshl_b32 s52, s48, 12
    s_add_u32 s51, s51, s52
    s_add_u32 s51, s51, 4096
    v_add_u32 v57, s51, v7
    v_add_u32 v55, 2224128, v57
    s_mov_b32 s45, 64
    s_lshl_b32 s51, s48, 7
    s_add_u32 s51, s51, 151552
    v_and_b32 v56, 1, v3
    v_lshlrev_b32 v56, 9, v56
    v_lshl_add_u32 v56, v2, 1, v56
    v_add_u32 v56, s51, v56
    v_and_b32 v8, 7, v1
    v_bfe_u32 v9, v1, 3, 1
    v_lshlrev_b32 v9, 10, v9
    v_lshl_add_u32 v10, v8, 11, v9
    s_lshl_b32 s51, s48, 14
    v_add_u32 v10, s51, v10
    v_lshlrev_b32 v8, 1, v8
    v_add_u32 v9, 0, v3
    v_xor_b32 v9, v9, v8
    v_lshl_add_u32 v84, v9, 4, v10
    v_add_u32 v9, 4, v3
    v_xor_b32 v9, v9, v8
    v_lshl_add_u32 v85, v9, 4, v10
    v_add_u32 v9, 8, v3
    v_xor_b32 v9, v9, v8
    v_lshl_add_u32 v86, v9, 4, v10
    v_add_u32 v9, 12, v3
    v_xor_b32 v9, v9, v8
    v_lshl_add_u32 v87, v9, 4, v10
    v_lshlrev_b32 v88, 9, v28
    v_lshl_add_u32 v88, v3, 4, v88
    v_add_u32 v88, 151552, v88
    s_and_b32 s53, s31, 7
    s_lshl_b32 s51, s100, 18
    s_lshl_b32 s52, s33, 13
    s_add_u32 s51, s51, s52
    s_lshl_b32 s52, s53, 9
    s_add_u32 s51, s51, s52
    s_lshl_b32 s52, s48, 7
    s_add_u32 s51, s51, s52
    s_add_u32 s51, s51, 36864
    v_lshlrev_b32 v89, 12, v3
    v_lshl_add_u32 v89, v2, 4, v89
    v_add_u32 v89, s51, v89
    s_lshl_b32 s51, s30, 18
    s_lshl_b32 s52, s31, 7
    s_add_u32 s51, s51, s52
    s_add_u32 s51, s51, 57344
    v_add_u32 v90, s51, v7
    v_mov_b32 v70, s58
    v_not_b32 v71, s58
L_wf_4:
    ds_read_b32 v8, v6 offset:0
    s_sub_u32 s50, s50, 1
    s_cbranch_scc1 L_end
    s_waitcnt lgkmcnt(0)
    v_cmp_gt_i32 vcc, 88, v8
    s_cbranch_vccnz L_wf_4
L_h1_5_f:
    s_sub_u32 s45, s45, 1
    s_cmp_lg_u32 s45, 0
    s_cbranch_scc1 L_h1k
    v_mov_b32 v55, v57
    s_cmp_eq_u32 s54, 7
    s_cbranch_scc1 L_h1k
    s_mov_b32 exec_lo, 0xffffffff
    s_mov_b32 exec_hi, 0x0
    global_store_dwordx4 v54, v[48:51], s[28:29] sc1
    s_mov_b64 exec, -1
L_h1k:
    v_mov_b32 v44, v4
    v_mov_b32 v45, v4
    v_mov_b32 v46, v4
    v_mov_b32 v47, v4
    global_load_dwordx4 v[32:35], v55, s[28:29] offset:0 sc1
    global_load_dwordx4 v[36:39], v55, s[28:29] offset:1024 sc1
    global_load_dwordx4 v[40:43], v55, s[28:29] offset:2048 sc1
    s_mov_b32 exec_lo, 0xffffffff
    s_mov_b32 exec_hi, 0x0
    global_load_dwordx4 v[44:47], v55, s[28:29] offset:3072 sc1
    s_mov_b64 exec, -1
L_wf_6:
    ds_read_b32 v8, v6 offset:0
    s_sub_u32 s50, s50, 1
    s_cbranch_scc1 L_end
    s_waitcnt lgkmcnt(0)
    v_cmp_gt_i32 vcc, 96, v8
    s_cbranch_vccnz L_wf_6
    ds_read_b128 v[96:99], v84 offset:0
    ds_read_b128 v[100:103], v85 offset:0
    ds_read_b128 v[104:107], v86 offset:0
    ds_read_b128 v[108:111], v87 offset:0
    ds_read_b128 v[112:115], v84 offset:256
    ds_read_b128 v[116:119], v85 offset:256
    ds_read_b128 v[120:123], v86 offset:256
    ds_read_b128 v[124:127], v87 offset:256
    ds_read_b128 v[128:131], v84 offset:512
    ds_read_b128 v[132:135], v85 offset:512
    ds_read_b128 v[136:139], v86 offset:512
    ds_read_b128 v[140:143], v87 offset:512
    ds_read_b128 v[144:147], v84 offset:768
    ds_read_b128 v[148:151], v85 offset:768
    ds_read_b128 v[152:155], v86 offset:768
    ds_read_b128 v[156:159], v87 offset:768
    s_waitcnt vmcnt(0)
    v_xor_b32 v32, v32, v4
    v_xor_b32 v33, v33, v4
    v_xor_b32 v34, v34, v4
    v_xor_b32 v35, v35, v4
    v_xor_b32 v36, v36, v4
    v_xor_b32 v37, v37, v4
    v_xor_b32 v38, v38, v4
    v_xor_b32 v39, v39, v4
    v_xor_b32 v40, v40, v4
    v_xor_b32 v41, v41, v4
    v_xor_b32 v42, v42, v4
    v_xor_b32 v43, v43, v4
    v_xor_b32 v44, v44, v4
    v_xor_b32 v45, v45, v4
    v_xor_b32 v46, v46, v4
    v_xor_b32 v47, v47, v4
    v_or3_b32 v64, v32, v33, v34
    v_or3_b32 v64, v64, v35, v36
    v_or3_b32 v64, v64, v37, v38
    v_or3_b32 v64, v64, v39, v40
    v_or3_b32 v64, v64, v41, v42
    v_or3_b32 v64, v64, v43, v44
    v_or3_b32 v64, v64, v45, v46
    v_or_b32 v64, v64, v47
    v_and_b32 v64, s39, v64
    v_cmp_ne_u32 vcc, 0, v64
    s_cbranch_vccnz L_h1_5
    v_pk_add_f32 v[32:33], v[32:33], v[36:37]
    v_pk_add_f32 v[40:41], v[40:41], v[44:45]
    v_pk_add_f32 v[34:35], v[34:35], v[38:39]
    v_pk_add_f32 v[42:43], v[42:43], v[46:47]
    v_pk_add_f32 v[32:33], v[32:33], v[40:41]
    v_pk_add_f32 v[34:35], v[34:35], v[42:43]
    v_mov_b32 v36, v32
    v_mov_b32 v37, v33
    v_mov_b32 v38, v34
    v_mov_b32 v39, v35
    v_permlane32_swap_b32 v32, v36
    v_permlane32_swap_b32 v33, v37
    v_permlane32_swap_b32 v34, v38
    v_permlane32_swap_b32 v35, v39
    v_add_f32 v32, v32, v36
    v_add_f32 v33, v33, v37
    v_add_f32 v34, v34, v38
    v_add_f32 v35, v35, v39
    v_cvt_pk_bf16_f32 v32, v32, v33
    v_cvt_pk_bf16_f32 v33, v34, v35
    ds_write_b16 v56, v32
    ds_write_b16_d16_hi v56, v32 offset:32
    ds_write_b16 v56, v33 offset:64
    ds_write_b16_d16_hi v56, v33 offset:96
    v_mov_b32 v12, 1
    ds_write_b32 v5, v12
    s_cmp_eq_u32 s54, 7
    s_cbranch_scc1 L_q1g
    s_mov_b32 exec_lo, 0xffffffff
    s_mov_b32 exec_hi, 0x0
    global_store_dwordx4 v54, v[48:51], s[28:29] sc1
    s_mov_b64 exec, -1
L_q1g:
L_wf_7:
    ds_read_b32 v8, v14 offset:0
    ds_read_b128 v[160:163], v88 offset:0
    ds_read_b128 v[164:167], v88 offset:64
    ds_read_b128 v[168:171], v88 offset:128
    ds_read_b128 v[172:175], v88 offset:192
    ds_read_b128 v[176:179], v88 offset:256
    ds_read_b128 v[180:183], v88 offset:320
    ds_read_b128 v[184:187], v88 offset:384
    ds_read_b128 v[188:191], v88 offset:448
    s_sub_u32 s50, s50, 1
    s_cbranch_scc1 L_end
    s_waitcnt lgkmcnt(8)
    v_cmp_gt_i32 vcc, 1, v8
    s_cbranch_vccnz L_wf_7
    s_waitcnt lgkmcnt(7)
    v_mfma_f32_16x16x32_bf16 v[72:75], v[160:163], v[96:99], 0
    v_mfma_f32_16x16x32_bf16 v[76:79], v[160:163], v[128:131], 0
    s_waitcnt lgkmcnt(6)
    v_mfma_f32_16x16x32_bf16 v[72:75], v[164:167], v[100:103], v[72:75]
    v_mfma_f32_16x16x32_bf16 v[76:79], v[164:167], v[132:135], v[76:79]
    s_waitcnt lgkmcnt(5)
    v_mfma_f32_16x16x32_bf16 v[72:75], v[168:171], v[104:107], v[72:75]
    v_mfma_f32_16x16x32_bf16 v[76:79], v[168:171], v[136:139], v[76:79]
    s_waitcnt lgkmcnt(4)
    v_mfma_f32_16x16x32_bf16 v[72:75], v[172:175], v[108:111], v[72:75]
    v_mfma_f32_16x16x32_bf16 v[76:79], v[172:175], v[140:143], v[76:79]
    s_waitcnt lgkmcnt(3)
    v_mfma_f32_16x16x32_bf16 v[72:75], v[176:179], v[112:115], v[72:75]
    v_mfma_f32_16x16x32_bf16 v[76:79], v[176:179], v[144:147], v[76:79]
    s_waitcnt lgkmcnt(2)
    v_mfma_f32_16x16x32_bf16 v[72:75], v[180:183], v[116:119], v[72:75]
    v_mfma_f32_16x16x32_bf16 v[76:79], v[180:183], v[148:151], v[76:79]
    s_waitcnt lgkmcnt(1)
    v_mfma_f32_16x16x32_bf16 v[72:75], v[184:187], v[120:123], v[72:75]
    v_mfma_f32_16x16x32_bf16 v[76:79], v[184:187], v[152:155], v[76:79]
    s_waitcnt lgkmcnt(0)
    v_mfma_f32_16x16x32_bf16 v[72:75], v[188:191], v[124:127], v[72:75]
    v_mfma_f32_16x16x32_bf16 v[76:79], v[188:191], v[156:159], v[76:79]
    v_mov_b32 v12, 2
    ds_write_b32 v5, v12
    s_nop 5
    v_cvt_pk_bf16_f32 v68, v72, v76
    s_nop 1
    v_mov_b32_dpp v69, v68 row_ror:8 row_mask:0xf bank_mask:0xf
    s_mov_b64 exec, 0xff00ff
    global_store_dwordx4 v89, v[68:71], s[28:29] sc1
    s_mov_b64 exec, -1
    s_cmp_lg_u32 s48, 0
    s_cbranch_scc1 L_np_8
    v_mov_b32 v8, s58
    s_mov_b64 exec, 15
    global_store_dwordx4 v90, v[8:11], s[28:29] sc1
    s_mov_b64 exec, -1
L_np_8:
    s_getreg_b32 s101, hwreg(HW_REG_XCC_ID)
    s_lshl_b32 s51, s30, 18
    s_lshl_b32 s52, s31, 7
    s_add_u32 s51, s51, s52
    s_add_u32 s51, s51, 63488
    v_add_u32 v13, s51, v7
    v_mov_b32 v9, s101
    s_cmp_lg_u32 s48, 1
    s_cbranch_scc1 L_np_9
    v_mov_b32 v8, s58
    s_mov_b64 exec, 15
    global_store_dwordx4 v13, v[8:11], s[28:29] sc1
    s_mov_b64 exec, -1
L_np_9:
    s_mul_i32 s34, s47, 9363
    s_lshr_b32 s34, s34, 16
    s_mul_i32 s35, s34, 7
    s_sub_u32 s35, s47, s35
    s_lshl_b32 s51, s35, 7
    v_add_u32 v30, s51, v31
    v_and_b32 v8, 7, v26
    v_lshl_add_u32 v9, v26, 8, v27
    s_lshr_b32 s51, s48, 1
    s_lshl_b32 s51, s51, 14
    s_add_u32 s51, s51, 94208
    v_add_u32 v9, s51, v9
    s_and_b32 s54, s48, 1
    s_lshl_b32 s51, s54, 2
    s_add_u32 s51, s51, 0
    v_xor_b32 v10, s51, v8
    v_lshl_add_u32 v72, v10, 5, v9
    s_lshl_b32 s51, s54, 2
    s_add_u32 s51, s51, 1
    v_xor_b32 v10, s51, v8
    v_lshl_add_u32 v73, v10, 5, v9
    s_lshl_b32 s51, s54, 2
    s_add_u32 s51, s51, 2
    v_xor_b32 v10, s51, v8
    v_lshl_add_u32 v74, v10, 5, v9
    s_lshl_b32 s51, s54, 2
    s_add_u32 s51, s51, 3
    v_xor_b32 v10, s51, v8
    v_lshl_add_u32 v75, v10, 5, v9
    s_lshl_b32 s51, s34, 1
    s_add_u32 s51, s51, s54
    s_lshl_b32 s51, s51, 1
    v_bfe_u32 v9, v1, 3, 1
    v_add_u32 v9, s51, v9
    v_and_b32 v76, 7, v9
    v_lshlrev_b32 v76, 18, v76
    v_lshrrev_b32 v9, 3, v9
    v_lshl_add_u32 v76, v9, 12, v76
    v_lshl_add_u32 v76, v3, 7, v76
    v_and_b32 v9, 7, v1
    v_lshl_add_u32 v76, v9, 4, v76
    s_lshr_b32 s54, s48, 1
    s_lshl_b32 s51, s35, 9
    s_lshl_b32 s52, s54, 8
    s_add_u32 s51, s51, s52
    s_add_u32 s51, s51, 67584
    v_add_u32 v76, s51, v76
    v_and_b32 v8, 7, v26
    v_lshrrev_b32 v9, 1, v3
    v_lshl_add_u32 v9, v8, 4, v9
    v_lshl_add_u32 v9, v9, 9, v27
    s_lshl_b32 s51, s48, 2
    s_add_u32 s51, s51, 0
    v_xor_b32 v10, s51, v8
    v_lshl_add_u32 v84, v10, 5, v9
    s_lshl_b32 s51, s48, 2
    s_add_u32 s51, s51, 1
    v_xor_b32 v10, s51, v8
    v_lshl_add_u32 v85, v10, 5, v9
    s_lshl_b32 s51, s48, 2
    s_add_u32 s51, s51, 2
    v_xor_b32 v10, s51, v8
    v_lshl_add_u32 v86, v10, 5, v9
    s_lshl_b32 s51, s48, 2
    s_add_u32 s51, s51, 3
    v_xor_b32 v10, s51, v8
    v_lshl_add_u32 v87, v10, 5, v9
    s_lshl_b32 s51, s32, 16
    s_lshl_b32 s52, s53, 13
    s_add_u32 s51, s51, s52
    s_lshl_b32 s52, s48, 11
    s_add_u32 s51, s51, s52
    s_add_u32 s51, s51, 4194304
    v_and_b32 v9, 1, v3
    v_lshlrev_b32 v9, 5, v9
    v_xor_b32 v80, v9, v7
    v_add_u32 v80, s51, v80
    v_add_u32 v81, 0x100000, v80
    s_lshl_b32 s54, s48, 12
    s_add_u32 s54, s54, 94208
    v_lshl_add_u32 v92, v26, 6, v27
    v_add_u32 v92, v92, v9
    v_add_u32 v92, s54, v92
    v_xor_b32 v93, 32, v92
    s_lshr_b32 s51, s58, 4
    s_and_b32 s51, s51, 3
    s_lshl_b32 s51, s51, 6
    s_not_b32 s52, s58
    s_and_b32 s52, s52, 3
    s_lshl_b32 s52, s52, 4
    s_or_b32 s51, s51, s52
    s_and_b32 s52, s58, 15
    s_or_b32 s51, s51, s52
    v_and_b32 v9, 7, v1
    v_lshrrev_b32 v20, v9, s51
    v_and_b32 v20, 1, v20
    v_mul_u32_u24 v20, 0x10001, v20
    s_lshl_b32 s51, s37, 8
    s_lshl_b32 s52, s32, 4
    s_add_u32 s51, s51, s52
    s_add_u32 s51, s51, 53248
    v_lshrrev_b32 v82, 3, v1
    v_lshlrev_b32 v82, 18, v82
    v_lshl_add_u32 v82, v9, 9, v82
    v_add_u32 v82, s51, v82
    v_lshlrev_b32 v83, 1, v1
    v_add_u32 v83, 152576, v83
    v_lshlrev_b32 v88, 6, v28
    v_lshl_add_u32 v88, v3, 3, v88
    v_add_u32 v88, 152576, v88
    v_add_u32 v90, 110592, v7
    s_lshl_b32 s51, s48, 10
    v_add_u32 v89, s51, v90
    s_lshl_b32 s51, s100, 18
    s_lshl_b32 s52, s33, 14
    s_add_u32 s51, s51, s52
    s_lshl_b32 s52, s48, 12
    s_add_u32 s51, s51, s52
    s_lshl_b32 s52, s53, 8
    s_add_u32 s51, s51, s52
    s_add_u32 s51, s51, 194560
    v_bfe_u32 v10, v1, 3, 1
    v_lshlrev_b32 v91, 11, v10
    v_lshl_add_u32 v91, v3, 7, v91
    v_lshl_add_u32 v91, v9, 4, v91
    v_add_u32 v91, s51, v91
    s_lshl_b32 s51, s48, 4
    v_add_u32 v8, s51, v2
    v_lshlrev_b32 v10, 1, v9
    v_add_u32 v10, s37, v10
    v_lshrrev_b32 v8, 3, v8
    v_lshlrev_b32 v8, 18, v8
    v_lshl_add_u32 v79, v10, 7, v8
    v_add_u32 v79, 61440, v79
    v_mov_b64 v[48:49], 0
    v_mov_b64 v[50:51], 0
    v_mov_b64 v[52:53], 0
    v_mov_b64 v[54:55], 0
    s_lshl_b32 s51, s30, 18
    s_lshl_b32 s52, s31, 13
    s_add_u32 s51, s51, s52
    s_lshl_b32 s52, s48, 11
    s_add_u32 s51, s51, s52
    s_add_u32 s51, s51, 2097152
    v_add_u32 v9, s51, v7
    global_load_dwordx4 v[32:35], v9, s[28:29] sc1
    global_load_dwordx4 v[36:39], v9, s[28:29] offset:1024 sc1
    s_mov_b32 exec_lo, 0xffffffff
    s_mov_b32 exec_hi, 0x0
    global_load_dwordx4 v[40:43], v91, s[28:29] sc1
    s_mov_b64 exec, -1
    s_lshl_b32 s51, s100, 18
    s_lshl_b32 s52, s33, 14
    s_add_u32 s51, s51, s52
    s_lshl_b32 s52, s53, 11
    s_add_u32 s51, s51, s52
    s_add_u32 s51, s51, 194560
    v_add_u32 v15, s51, v7
    v_lshlrev_b32 v21, 5, v28
    v_lshl_add_u32 v21, v3, 2, v21
    v_add_u32 v22, 16, v21
    v_and_b32 v8, 3, v26
    v_lshl_add_u32 v9, v8, 3, v3
    v_mul_u32_u24 v9, 896, v9
    v_add_u32 v9, v9, v27
    v_add_u32 v9, 65536, v9
    s_mul_i32 s51, s48, 7
    s_add_u32 s51, s51, 0
    v_xor_b32 v10, s51, v8
    v_lshl_add_u32 v232, v10, 5, v9
    s_mul_i32 s51, s48, 7
    s_add_u32 s51, s51, 1
    v_xor_b32 v10, s51, v8
    v_lshl_add_u32 v233, v10, 5, v9
    s_mul_i32 s51, s48, 7
    s_add_u32 s51, s51, 2
    v_xor_b32 v10, s51, v8
    v_lshl_add_u32 v234, v10, 5, v9
    s_mul_i32 s51, s48, 7
    s_add_u32 s51, s51, 3
    v_xor_b32 v10, s51, v8
    v_lshl_add_u32 v235, v10, 5, v9
    s_mul_i32 s51, s48, 7
    s_add_u32 s51, s51, 4
    v_xor_b32 v10, s51, v8
    v_lshl_add_u32 v236, v10, 5, v9
    s_mul_i32 s51, s48, 7
    s_add_u32 s51, s51, 5
    v_xor_b32 v10, s51, v8
    v_lshl_add_u32 v237, v10, 5, v9
    s_mul_i32 s51, s48, 7
    s_add_u32 s51, s51, 6
    v_xor_b32 v10, s51, v8
    v_lshl_add_u32 v238, v10, 5, v9
    v_and_b32 v9, 7, v26
    v_lshlrev_b32 v9, 18, v9
    v_lshl_add_u32 v9, v27, 1, v9
    v_lshrrev_b32 v10, 5, v1
    s_lshl_b32 s51, s48, 14
    s_lshl_b32 s52, s46, 6
    s_add_u32 s51, s51, s52
    s_add_u32 s51, s51, 129024
    v_lshl_add_u32 v23, v10, 13, v9
    v_add_u32 v23, s51, v23
    s_lshl_b32 s51, s30, 18
    s_lshl_b32 s52, s31, 13
    s_add_u32 s51, s51, s52
    s_lshl_b32 s52, s48, 11
    s_add_u32 s51, s51, s52
    s_add_u32 s51, s51, 63488
    v_add_u32 v25, s51, v7
    s_lshl_b32 s51, s48, 6
    s_add_u32 s51, s51, 152704
    v_add_u32 v19, s51, v7
    s_and_b32 s53, s31, 8
    s_lshl_b32 s51, s30, 18
    s_lshl_b32 s52, s53, 7
    s_add_u32 s51, s51, s52
    s_add_u32 s51, s51, 63488
    v_and_b32 v18, 7, v1
    v_lshl_add_u32 v18, v18, 7, s51
    s_waitcnt vmcnt(0)
    s_cmp_lg_u32 s49, 32
    s_cbranch_scc1 L_nogu
    ds_read2_b64 v[32:35], v30 offset0:0 offset1:4
    ds_read2_b64 v[36:39], v30 offset0:8 offset1:12
L_wf_10:
    ds_read_b32 v8, v6 offset:0
    s_sub_u32 s50, s50, 1
    s_cbranch_scc1 L_end
    s_sleep 2
    s_waitcnt lgkmcnt(0)
    v_cmp_gt_i32 vcc, 128, v8
    s_cbranch_vccnz L_wf_10
    ds_read_b64_tr_b16 v[96:97], v72 offset:0
    ds_read_b64_tr_b16 v[98:99], v72 offset:4096
    ds_read_b64_tr_b16 v[100:101], v72 offset:8192
    ds_read_b64_tr_b16 v[102:103], v72 offset:12288
    ds_read_b64_tr_b16 v[104:105], v73 offset:0
    ds_read_b64_tr_b16 v[106:107], v73 offset:4096
    ds_read_b64_tr_b16 v[108:109], v73 offset:8192
    ds_read_b64_tr_b16 v[110:111], v73 offset:12288
    ds_read_b64_tr_b16 v[112:113], v74 offset:0
    ds_read_b64_tr_b16 v[114:115], v74 offset:4096
    ds_read_b64_tr_b16 v[116:117], v74 offset:8192
    ds_read_b64_tr_b16 v[118:119], v74 offset:12288
    ds_read_b64_tr_b16 v[120:121], v75 offset:0
    ds_read_b64_tr_b16 v[122:123], v75 offset:4096
    ds_read_b64_tr_b16 v[124:125], v75 offset:8192
    ds_read_b64_tr_b16 v[126:127], v75 offset:12288
    s_waitcnt lgkmcnt(0)
    v_mfma_f32_16x16x32_bf16 v[160:163], v[32:35], v[96:99], 0
    v_mfma_f32_16x16x32_bf16 v[164:167], v[32:35], v[104:107], 0
    v_mfma_f32_16x16x32_bf16 v[168:171], v[32:35], v[112:115], 0
    v_mfma_f32_16x16x32_bf16 v[172:175], v[32:35], v[120:123], 0
    v_mfma_f32_16x16x32_bf16 v[160:163], v[36:39], v[100:103], v[160:163]
    v_mfma_f32_16x16x32_bf16 v[164:167], v[36:39], v[108:111], v[164:167]
    v_mfma_f32_16x16x32_bf16 v[168:171], v[36:39], v[116:119], v[168:171]
    v_mfma_f32_16x16x32_bf16 v[172:175], v[36:39], v[124:127], v[172:175]
    s_nop 4
    v_bfi_b32 v56, s39, v4, v160
    v_bfi_b32 v57, s39, v4, v164
    v_bfi_b32 v58, s39, v4, v168
    v_bfi_b32 v59, s39, v4, v172
    s_mov_b32 exec_lo, 0xffffffff
    s_mov_b32 exec_hi, 0x0
    global_store_dwordx4 v76, v[56:59], s[28:29] sc1
    s_mov_b64 exec, -1
L_nogu:
    global_load_dwordx2 v[16:17], v18, s[28:29] sc1
    s_add_u32 s53, s49, 160
L_wf_11:
    ds_read_b32 v8, v6 offset:0
    s_sub_u32 s50, s50, 1
    s_cbranch_scc1 L_end
    s_sleep 1
    s_waitcnt lgkmcnt(0)
    v_cmp_gt_i32 vcc, s53, v8
    s_cbranch_vccnz L_wf_11
    ds_read_b64_tr_b16 v[96:97], v84 offset:0
    ds_read_b64_tr_b16 v[98:99], v84 offset:1024
    ds_read_b64_tr_b16 v[100:101], v84 offset:2048
    ds_read_b64_tr_b16 v[102:103], v84 offset:3072
    ds_read_b64_tr_b16 v[104:105], v84 offset:4096
    ds_read_b64_tr_b16 v[106:107], v84 offset:5120
    ds_read_b64_tr_b16 v[108:109], v84 offset:6144
    ds_read_b64_tr_b16 v[110:111], v84 offset:7168
    ds_read_b64_tr_b16 v[112:113], v85 offset:0
    ds_read_b64_tr_b16 v[114:115], v85 offset:1024
    ds_read_b64_tr_b16 v[116:117], v85 offset:2048
    ds_read_b64_tr_b16 v[118:119], v85 offset:3072
    ds_read_b64_tr_b16 v[120:121], v85 offset:4096
    ds_read_b64_tr_b16 v[122:123], v85 offset:5120
    ds_read_b64_tr_b16 v[124:125], v85 offset:6144
    ds_read_b64_tr_b16 v[126:127], v85 offset:7168
    ds_read_b64_tr_b16 v[128:129], v86 offset:0
    ds_read_b64_tr_b16 v[130:131], v86 offset:1024
    ds_read_b64_tr_b16 v[132:133], v86 offset:2048
    ds_read_b64_tr_b16 v[134:135], v86 offset:3072
    ds_read_b64_tr_b16 v[136:137], v86 offset:4096
    ds_read_b64_tr_b16 v[138:139], v86 offset:5120
    ds_read_b64_tr_b16 v[140:141], v86 offset:6144
    ds_read_b64_tr_b16 v[142:143], v86 offset:7168
    ds_read_b64_tr_b16 v[144:145], v87 offset:0
    ds_read_b64_tr_b16 v[146:147], v87 offset:1024
    ds_read_b64_tr_b16 v[148:149], v87 offset:2048
    ds_read_b64_tr_b16 v[150:151], v87 offset:3072
    ds_read_b64_tr_b16 v[152:153], v87 offset:4096
    ds_read_b64_tr_b16 v[154:155], v87 offset:5120
    ds_read_b64_tr_b16 v[156:157], v87 offset:6144
    ds_read_b64_tr_b16 v[158:159], v87 offset:7168
    s_add_u32 s53, s53, 28
    s_waitcnt vmcnt(0)
    v_xor_b32 v16, s58, v16
    v_xor_b32 v17, s101, v17
    v_or_b32 v16, v16, v17
    v_cmp_ne_u32 vcc, 0, v16
    s_cmp_eq_u64 vcc, 0
    s_cselect_b32 s101, 1, 0
    s_mov_b64 exec, 0xffff
L_sn_12:
    global_load_dword v13, v79, s[28:29] sc1
    s_sub_u32 s50, s50, 1
    s_cbranch_scc1 L_end
    s_waitcnt vmcnt(0)
    v_cmp_ne_u32 vcc, s58, v13
    s_cbranch_vccnz L_sn_12
    s_mov_b64 exec, -1
    s_waitcnt lgkmcnt(0)
    v_mov_b32 v12, 3
    ds_write_b32 v5, v12
L_wf_13:
    ds_read_b32 v8, v14 offset:0
    s_sub_u32 s50, s50, 1
    s_cbranch_scc1 L_end
    s_waitcnt lgkmcnt(0)
    v_cmp_gt_i32 vcc, 3, v8
    s_cbranch_vccnz L_wf_13
    s_cmp_lg_u32 s48, 0
    s_cbranch_scc1 L_h3r_f
L_h3_14_f:
    global_load_dwordx4 v[64:67], v82, s[28:29] sc1
    s_add_u32 m0, s54, 0
    s_nop 0
    global_load_lds_dwordx4 v80, s[28:29] offset:0 sc1
    global_load_lds_dwordx4 v80, s[28:29] offset:1024 sc1
    s_add_u32 m0, s54, 2048
    s_nop 0
    global_load_lds_dwordx4 v81, s[28:29] offset:0 sc1
    global_load_lds_dwordx4 v81, s[28:29] offset:1024 sc1
    v_mov_b32 v12, 4
    ds_write_b32 v5, v12
    s_waitcnt vmcnt(4)
    v_xor_b32 v66, s58, v66
    v_xnor_b32 v67, s58, v67
    v_or_b32 v67, v66, v67
    v_mov_b32 v66, v64
    v_cmp_ne_u32 vcc, 0, v67
    s_cbranch_vccnz L_h3_14
    v_max_f32_dpp v66, v66, v66 row_ror:8 row_mask:0xf bank_mask:0xf
    s_nop 1
    v_max_f32_dpp v66, v66, v66 row_ror:4 row_mask:0xf bank_mask:0xf
    s_nop 1
    v_max_f32_dpp v66, v66, v66 row_ror:2 row_mask:0xf bank_mask:0xf
    s_nop 1
    v_max_f32_dpp v66, v66, v66 row_ror:1 row_mask:0xf bank_mask:0xf
    v_mov_b32 v67, v66
    s_nop 1
    v_permlane16_swap_b32 v66, v67
    v_max_f32 v66, v66, v67
    v_sub_f32 v64, v64, v66
    v_exp_f32 v64, v64
    s_nop 0
    v_mul_f32 v65, v64, v65
    s_nop 1
    v_add_f32_dpp v65, v65, v65 row_ror:8 row_mask:0xf bank_mask:0xf
    s_nop 1
    v_add_f32_dpp v65, v65, v65 row_ror:4 row_mask:0xf bank_mask:0xf
    s_nop 1
    v_add_f32_dpp v65, v65, v65 row_ror:2 row_mask:0xf bank_mask:0xf
    s_nop 1
    v_add_f32_dpp v65, v65, v65 row_ror:1 row_mask:0xf bank_mask:0xf
    v_mov_b32 v67, v65
    s_nop 1
    v_permlane16_swap_b32 v65, v67
    v_add_f32 v65, v65, v67
    v_rcp_f32 v65, v65
    s_nop 0
    v_mul_f32 v64, v64, v65
    v_cvt_pk_bf16_f32 v64, v64, v64
    ds_write_b16 v83, v64
    v_mov_b32 v12, 5
    ds_write_b32 v5, v12
    s_branch L_h3w
L_h3r:
    s_sub_u32 s50, s50, 1
    s_cbranch_scc1 L_end
    s_add_u32 m0, s54, 0
    s_nop 0
    global_load_lds_dwordx4 v80, s[28:29] offset:0 sc1
    global_load_lds_dwordx4 v80, s[28:29] offset:1024 sc1
    s_add_u32 m0, s54, 2048
    s_nop 0
    global_load_lds_dwordx4 v81, s[28:29] offset:0 sc1
    global_load_lds_dwordx4 v81, s[28:29] offset:1024 sc1
    s_branch L_h3w
L_h3r_f:
    s_add_u32 m0, s54, 0
    s_nop 0
    global_load_lds_dwordx4 v80, s[28:29] offset:0 sc1
    global_load_lds_dwordx4 v80, s[28:29] offset:1024 sc1
    s_add_u32 m0, s54, 2048
    s_nop 0
    global_load_lds_dwordx4 v81, s[28:29] offset:0 sc1
    global_load_lds_dwordx4 v81, s[28:29] offset:1024 sc1
    v_mov_b32 v12, 4
    ds_write_b32 v5, v12
L_h3w:
    s_waitcnt vmcnt(0)
    ds_read_b64_tr_b16 v[32:33], v92 offset:0
    ds_read_b64_tr_b16 v[34:35], v92 offset:1024
    ds_read_b64_tr_b16 v[36:37], v93 offset:0
    ds_read_b64_tr_b16 v[38:39], v93 offset:1024
    ds_read_b64_tr_b16 v[40:41], v92 offset:2048
    ds_read_b64_tr_b16 v[42:43], v92 offset:3072
    ds_read_b64_tr_b16 v[44:45], v93 offset:2048
    ds_read_b64_tr_b16 v[46:47], v93 offset:3072
    s_waitcnt lgkmcnt(0)
    v_xor_b32 v32, v32, v20
    v_xor_b32 v33, v33, v20
    v_xor_b32 v34, v34, v20
    v_xor_b32 v35, v35, v20
    v_xor_b32 v36, v36, v20
    v_xor_b32 v37, v37, v20
    v_xor_b32 v38, v38, v20
    v_xor_b32 v39, v39, v20
    v_xor_b32 v40, v40, v20
    v_xor_b32 v41, v41, v20
    v_xor_b32 v42, v42, v20
    v_xor_b32 v43, v43, v20
    v_xor_b32 v44, v44, v20
    v_xor_b32 v45, v45, v20
    v_xor_b32 v46, v46, v20
    v_xor_b32 v47, v47, v20
    v_or3_b32 v68, v32, v33, v34
    v_or3_b32 v68, v68, v35, v36
    v_or3_b32 v68, v68, v37, v38
    v_or3_b32 v68, v68, v39, v40
    v_or3_b32 v68, v68, v41, v42
    v_or3_b32 v68, v68, v43, v44
    v_or3_b32 v68, v68, v45, v46
    v_or_b32 v68, v68, v47
    v_and_b32 v68, 0x00010001, v68
    v_cmp_ne_u32 vcc, 0, v68
    s_cbranch_vccnz L_h3r
L_wf_15:
    ds_read_b32 v8, v6 offset:16
    ds_read2_b64 v[60:63], v88 offset0:0 offset1:4
    s_sub_u32 s50, s50, 1
    s_cbranch_scc1 L_end
    s_waitcnt lgkmcnt(1)
    v_cmp_gt_i32 vcc, 5, v8
    s_cbranch_vccnz L_wf_15
    s_waitcnt lgkmcnt(0)
    s_mov_b32 exec_lo, 0xf0f0f0f
    s_mov_b32 exec_hi, 0xf0f0f0f
    v_mov_b64 v[48:49], v[60:61]
    v_mov_b64 v[50:51], v[62:63]
    s_mov_b32 exec_lo, 0xf0f0f0f0
    s_mov_b32 exec_hi, 0xf0f0f0f0
    v_mov_b64 v[52:53], v[60:61]
    v_mov_b64 v[54:55], v[62:63]
    s_mov_b64 exec, -1
    v_mfma_f32_16x16x32_bf16 v[56:59], v[32:35], v[48:51], 0
    v_mfma_f32_16x16x32_bf16 v[60:63], v[36:39], v[48:51], 0
    v_mfma_f32_16x16x32_bf16 v[56:59], v[40:43], v[52:55], v[56:59]
    v_mfma_f32_16x16x32_bf16 v[60:63], v[44:47], v[52:55], v[60:63]
    s_nop 6
    v_cvt_pk_bf16_f32 v64, v56, v57
    v_cvt_pk_bf16_f32 v65, v58, v59
    v_cvt_pk_bf16_f32 v66, v60, v61
    v_cvt_pk_bf16_f32 v67, v62, v63
    ds_write_b128 v89, v[64:67]
    v_mov_b32 v12, 6
    ds_write_b32 v5, v12
L_wf_16:
    ds_read_b32 v8, v14 offset:0
    ds_read_b128 v[32:35], v90 offset:0
    ds_read_b128 v[36:39], v90 offset:1024
    ds_read_b128 v[40:43], v90 offset:2048
    ds_read_b128 v[44:47], v90 offset:3072
    s_sub_u32 s50, s50, 1
    s_cbranch_scc1 L_end
    s_waitcnt lgkmcnt(4)
    v_cmp_gt_i32 vcc, 6, v8
    s_cbranch_vccnz L_wf_16
    s_waitcnt lgkmcnt(3)
    v_mfma_f32_16x16x32_bf16 v[160:163], v[32:35], v[96:99], 0
    v_mfma_f32_16x16x32_bf16 v[164:167], v[32:35], v[112:115], 0
    v_mfma_f32_16x16x32_bf16 v[168:171], v[32:35], v[128:131], 0
    v_mfma_f32_16x16x32_bf16 v[172:175], v[32:35], v[144:147], 0
    s_waitcnt lgkmcnt(2)
    v_mfma_f32_16x16x32_bf16 v[160:163], v[36:39], v[100:103], v[160:163]
    v_mfma_f32_16x16x32_bf16 v[164:167], v[36:39], v[116:119], v[164:167]
    v_mfma_f32_16x16x32_bf16 v[168:171], v[36:39], v[132:135], v[168:171]
    v_mfma_f32_16x16x32_bf16 v[172:175], v[36:39], v[148:151], v[172:175]
    s_waitcnt lgkmcnt(1)
    v_mfma_f32_16x16x32_bf16 v[160:163], v[40:43], v[104:107], v[160:163]
    v_mfma_f32_16x16x32_bf16 v[164:167], v[40:43], v[120:123], v[164:167]
    v_mfma_f32_16x16x32_bf16 v[168:171], v[40:43], v[136:139], v[168:171]
    v_mfma_f32_16x16x32_bf16 v[172:175], v[40:43], v[152:155], v[172:175]
    s_waitcnt lgkmcnt(0)
    v_mfma_f32_16x16x32_bf16 v[160:163], v[44:47], v[108:111], v[160:163]
    v_mfma_f32_16x16x32_bf16 v[164:167], v[44:47], v[124:127], v[164:167]
    v_mfma_f32_16x16x32_bf16 v[168:171], v[44:47], v[140:143], v[168:171]
    v_mfma_f32_16x16x32_bf16 v[172:175], v[44:47], v[156:159], v[172:175]
    s_nop 4
    v_bfi_b32 v56, s39, v4, v160
    v_bfi_b32 v57, s39, v4, v164
    v_bfi_b32 v58, s39, v4, v168
    v_bfi_b32 v59, s39, v4, v172
    s_mov_b32 exec_lo, 0xffffffff
    s_mov_b32 exec_hi, 0x0
    s_cmp_lg_u32 s101, 0
    s_cbranch_scc1 L_cxl
    global_store_dwordx4 v91, v[56:59], s[28:29] sc1
    s_branch L_cxd
L_cxl:
    global_store_dwordx4 v91, v[56:59], s[28:29]
L_cxd:
    s_mov_b64 exec, -1
L_wf_17:
    ds_read_b32 v8, v6 offset:0
    s_sub_u32 s50, s50, 1
    s_cbranch_scc1 L_end
    s_waitcnt lgkmcnt(0)
    v_cmp_gt_i32 vcc, s53, v8
    s_cbranch_vccnz L_wf_17
    ds_read_b64_tr_b16 v[192:193], v232 offset:0
    ds_read_b64_tr_b16 v[194:195], v232 offset:3584
    ds_read_b64_tr_b16 v[196:197], v233 offset:0
    ds_read_b64_tr_b16 v[198:199], v233 offset:3584
    ds_read_b64_tr_b16 v[200:201], v234 offset:0
    ds_read_b64_tr_b16 v[202:203], v234 offset:3584
    ds_read_b64_tr_b16 v[204:205], v235 offset:0
    ds_read_b64_tr_b16 v[206:207], v235 offset:3584
    ds_read_b64_tr_b16 v[208:209], v236 offset:0
    ds_read_b64_tr_b16 v[210:211], v236 offset:3584
    ds_read_b64_tr_b16 v[212:213], v237 offset:0
    ds_read_b64_tr_b16 v[214:215], v237 offset:3584
    ds_read_b64_tr_b16 v[216:217], v238 offset:0
    ds_read_b64_tr_b16 v[218:219], v238 offset:3584
    s_waitcnt vmcnt(0)
L_h4_18_f:
    global_load_dwordx4 v[32:35], v15, s[28:29] offset:0 sc1
    global_load_dwordx4 v[36:39], v15, s[28:29] offset:1024 sc1
    s_waitcnt vmcnt(0)
    v_xor_b32 v32, v32, v4
    v_xor_b32 v33, v33, v4
    v_xor_b32 v34, v34, v4
    v_xor_b32 v35, v35, v4
    v_xor_b32 v36, v36, v4
    v_xor_b32 v37, v37, v4
    v_xor_b32 v38, v38, v4
    v_xor_b32 v39, v39, v4
    v_or3_b32 v48, v32, v33, v34
    v_or3_b32 v48, v48, v35, v36
    v_or3_b32 v48, v48, v37, v38
    v_or_b32 v48, v48, v39
    v_and_b32 v48, s39, v48
    v_cmp_ne_u32 vcc, 0, v48
    s_cbranch_vccnz L_h4_18
    v_mov_b32 v12, 7
    ds_write_b32 v5, v12
    v_pk_add_f32 v[32:33], v[32:33], v[36:37]
    v_pk_add_f32 v[34:35], v[34:35], v[38:39]
    v_mov_b32 v36, v32
    v_mov_b32 v37, v33
    v_mov_b32 v38, v34
    v_mov_b32 v39, v35
    v_permlane16_swap_b32 v32, v36
    v_permlane16_swap_b32 v33, v37
    v_permlane16_swap_b32 v34, v38
    v_permlane16_swap_b32 v35, v39
    v_add_f32 v32, v32, v36
    v_add_f32 v33, v33, v37
    v_add_f32 v34, v34, v38
    v_add_f32 v35, v35, v39
    v_mov_b32 v36, v32
    v_mov_b32 v37, v33
    v_mov_b32 v38, v34
    v_mov_b32 v39, v35
    v_permlane32_swap_b32 v32, v36
    v_permlane32_swap_b32 v33, v37
    v_permlane32_swap_b32 v34, v38
    v_permlane32_swap_b32 v35, v39
    v_add_f32 v32, v32, v36
    v_add_f32 v33, v33, v37
    v_add_f32 v34, v34, v38
    v_add_f32 v35, v35, v39
    v_cvt_pk_bf16_f32 v32, v32, v33
    v_cvt_pk_bf16_f32 v33, v34, v35
    ds_bpermute_b32 v36, v21, v32
    ds_bpermute_b32 v37, v21, v33
    ds_bpermute_b32 v38, v22, v32
    ds_bpermute_b32 v39, v22, v33
    s_waitcnt lgkmcnt(0)
    v_mfma_f32_16x16x32_bf16 v[160:163], v[36:39], v[192:195], 0
    v_mfma_f32_16x16x32_bf16 v[164:167], v[36:39], v[196:199], 0
    v_mfma_f32_16x16x32_bf16 v[168:171], v[36:39], v[200:203], 0
    v_mfma_f32_16x16x32_bf16 v[172:175], v[36:39], v[204:207], 0
    v_mfma_f32_16x16x32_bf16 v[176:179], v[36:39], v[208:211], 0
    v_mfma_f32_16x16x32_bf16 v[180:183], v[36:39], v[212:215], 0
    v_mfma_f32_16x16x32_bf16 v[184:187], v[36:39], v[216:219], 0
    s_nop 1
    v_bfi_b32 v56, s39, v4, v160
    v_bfi_b32 v57, s39, v4, v164
    v_bfi_b32 v58, s39, v4, v168
    v_bfi_b32 v59, s39, v4, v172
    s_mov_b32 exec_lo, 0
    v_bfi_b32 v56, s39, v4, v176
    v_bfi_b32 v57, s39, v4, v180
    v_bfi_b32 v58, s39, v4, v184
    s_mov_b32 exec_lo, -1
    global_store_dwordx4 v23, v[56:59], s[28:29] sc1
    s_cmp_lt_u32 s46, 64
    s_cbranch_scc1 L_cdone
    s_waitcnt vmcnt(0)
L_h5_19_f:
    global_load_dwordx4 v[32:35], v25, s[28:29] offset:0 sc1
    global_load_dwordx4 v[36:39], v25, s[28:29] offset:1024 sc1
    s_waitcnt vmcnt(0)
    v_xor_b32 v32, v32, v4
    v_xor_b32 v33, v33, v4
    v_xor_b32 v34, v34, v4
    v_xor_b32 v35, v35, v4
    v_xor_b32 v36, v36, v4
    v_xor_b32 v37, v37, v4
    v_xor_b32 v38, v38, v4
    v_xor_b32 v39, v39, v4
    v_or3_b32 v48, v32, v33, v34
    v_or3_b32 v48, v48, v35, v36
    v_or3_b32 v48, v48, v37, v38
    v_or_b32 v48, v48, v39
    v_and_b32 v48, s39, v48
    v_cmp_ne_u32 vcc, 0, v48
    s_cbranch_vccnz L_h5_19
    v_pk_add_f32 v[32:33], v[32:33], v[36:37]
    v_pk_add_f32 v[34:35], v[34:35], v[38:39]
    s_nop 0
    v_add_f32_dpp v32, v32, v32 row_ror:4 row_mask:0xf bank_mask:0xf
    v_add_f32_dpp v33, v33, v33 row_ror:4 row_mask:0xf bank_mask:0xf
    v_add_f32_dpp v34, v34, v34 row_ror:4 row_mask:0xf bank_mask:0xf
    v_add_f32_dpp v35, v35, v35 row_ror:4 row_mask:0xf bank_mask:0xf
    v_add_f32_dpp v32, v32, v32 row_ror:8 row_mask:0xf bank_mask:0xf
    v_add_f32_dpp v33, v33, v33 row_ror:8 row_mask:0xf bank_mask:0xf
    v_add_f32_dpp v34, v34, v34 row_ror:8 row_mask:0xf bank_mask:0xf
    v_add_f32_dpp v35, v35, v35 row_ror:8 row_mask:0xf bank_mask:0xf
    v_mov_b32 v36, v32
    v_mov_b32 v37, v33
    v_mov_b32 v38, v34
    v_mov_b32 v39, v35
    v_permlane16_swap_b32 v32, v36
    v_permlane16_swap_b32 v33, v37
    v_permlane16_swap_b32 v34, v38
    v_permlane16_swap_b32 v35, v39
    v_add_f32 v32, v32, v36
    v_add_f32 v33, v33, v37
    v_add_f32 v34, v34, v38
    v_add_f32 v35, v35, v39
    v_mov_b32 v36, v32
    v_mov_b32 v37, v33
    v_mov_b32 v38, v34
    v_mov_b32 v39, v35
    v_permlane32_swap_b32 v32, v36
    v_permlane32_swap_b32 v33, v37
    v_permlane32_swap_b32 v34, v38
    v_permlane32_swap_b32 v35, v39
    v_add_f32 v32, v32, v36
    v_add_f32 v33, v33, v37
    v_add_f32 v34, v34, v38
    v_add_f32 v35, v35, v39
    s_mov_b64 exec, 15
    ds_write_b128 v19, v[32:35]
    s_mov_b64 exec, -1
    v_mov_b32 v12, 8
    ds_write_b32 v5, v12
L_cdone:
    s_endpgm
L_h1_5:
    s_sub_u32 s50, s50, 1
    s_cbranch_scc1 L_end
    s_branch L_h1_5_f
L_h3_14:
    s_sub_u32 s50, s50, 1
    s_cbranch_scc1 L_end
    s_branch L_h3_14_f
L_h4_18:
    s_sub_u32 s50, s50, 1
    s_cbranch_scc1 L_end
    s_branch L_h4_18_f
L_h5_19:
    s_sub_u32 s50, s50, 1
    s_cbranch_scc1 L_end
    s_branch L_h5_19_f
L_comp2:
    v_and_b32 v2, 15, v1
    v_lshrrev_b32 v26, 2, v1
    v_and_b32 v27, 3, v1
    v_lshlrev_b32 v27, 3, v27
    s_mov_b32 s39, 0xfff
    s_and_b32 s34, s30, 3
    s_lshl_b32 s34, s34, 3
    s_lshr_b32 s51, s31, 1
    s_add_u32 s34, s34, s51
    s_and_b32 s35, s31, 1
    s_mov_b32 s59, 0x3db8aa3b
    s_getreg_b32 s101, hwreg(HW_REG_XCC_ID)
    s_lshl_b32 s51, s30, 18
    s_lshl_b32 s52, s31, 13
    s_add_u32 s51, s51, s52
    s_lshl_b32 s52, s48, 11
    s_add_u32 s51, s51, s52
    s_add_u32 s51, s51, 2097152
    v_add_u32 v57, s51, v7
    v_xor_b32 v58, 0x2000, v57
    s_xor_b32 s53, s31, 1
    s_lshl_b32 s51, s30, 18
    s_lshl_b32 s52, s53, 7
    s_add_u32 s51, s51, s52
    s_add_u32 s51, s51, 59392
    v_mov_b32 v59, s51
    v_lshlrev_b32 v61, 2, v2
    v_add_u32 v61, 152576, v61
    v_mov_b32 v9, 0xff800000
    ds_write_b32 v61, v9
    s_waitcnt lgkmcnt(0)
    s_add_u32 s58, s55, 1
    s_and_b32 s38, s58, 0xfff
    v_mov_b32 v4, s38
    s_cmp_lg_u32 s48, 0
    s_cbranch_scc1 L_noxid
    s_lshl_b32 s51, s30, 18
    s_lshl_b32 s52, s31, 7
    s_add_u32 s51, s51, s52
    s_add_u32 s51, s51, 59392
    v_add_u32 v13, s51, v7
    v_mov_b32 v9, s101
    v_mov_b32 v8, s58
    s_mov_b64 exec, 15
    global_store_dwordx4 v13, v[8:11], s[28:29] sc1
    s_mov_b64 exec, -1
L_noxid:
    s_lshr_b32 s53, s58, 4
    s_and_b32 s53, s53, 3
    s_lshl_b32 s53, s53, 6
    s_not_b32 s52, s58
    s_and_b32 s52, s52, 3
    s_lshl_b32 s52, s52, 4
    s_or_b32 s53, s53, s52
    s_and_b32 s52, s58, 15
    s_or_b32 s53, s53, s52
    s_lshr_b32 s51, s53, 0
    s_and_b32 s52, s51, 2
    s_lshl_b32 s52, s52, 15
    s_and_b32 s51, s51, 1
    s_or_b32 s51, s51, s52
    v_mov_b32 v20, s51
    s_lshr_b32 s51, s53, 2
    s_and_b32 s52, s51, 2
    s_lshl_b32 s52, s52, 15
    s_and_b32 s51, s51, 1
    s_or_b32 s51, s51, s52
    v_mov_b32 v21, s51
    s_lshr_b32 s51, s53, 4
    s_and_b32 s52, s51, 2
    s_lshl_b32 s52, s52, 15
    s_and_b32 s51, s51, 1
    s_or_b32 s51, s51, s52
    v_mov_b32 v22, s51
    s_lshr_b32 s51, s53, 6
    s_and_b32 s52, s51, 2
    s_lshl_b32 s52, s52, 15
    s_and_b32 s51, s51, 1
    s_or_b32 s51, s51, s52
    v_mov_b32 v23, s51
    s_lshl_b32 s51, s33, 20
    s_lshl_b32 s52, s35, 15
    s_add_u32 s51, s51, s52
    s_lshl_b32 s52, s48, 13
    s_add_u32 s51, s51, s52
    s_lshl_b32 s52, s34, 6
    s_add_u32 s51, s51, s52
    s_add_u32 s51, s51, 4194304
    v_lshlrev_b32 v28, 18, v3
    v_bfe_u32 v9, v1, 2, 2
    v_lshl_add_u32 v28, v9, 11, v28
    v_lshl_add_u32 v28, v27, 1, v28
    v_add_u32 v28, s51, v28
    v_add_u32 v29, 65536, v28
    v_add_u32 v30, 131072, v28
    v_add_u32 v31, 196608, v28
    s_lshl_b32 s51, s30, 18
    s_lshl_b32 s52, s31, 8
    s_add_u32 s51, s51, s52
    s_add_u32 s51, s51, 53248
    v_add_u32 v25, s51, v7
    s_lshl_b32 s51, s30, 18
    s_lshl_b32 s52, s31, 7
    s_add_u32 s51, s51, s52
    s_add_u32 s51, s51, 61440
    v_add_u32 v24, s51, v7
    v_and_b32 v8, 7, v1
    v_lshlrev_b32 v8, 1, v8
    s_lshl_b32 s51, s48, 14
    v_add_u32 v9, 0, v3
    v_xor_b32 v9, v9, v8
    v_lshlrev_b32 v9, 4, v9
    v_lshl_add_u32 v9, v2, 10, v9
    v_add_u32 v40, 131072, v9
    v_add_u32 v44, s51, v9
    v_add_u32 v16, 0x10000, v44
    v_add_u32 v9, 4, v3
    v_xor_b32 v9, v9, v8
    v_lshlrev_b32 v9, 4, v9
    v_lshl_add_u32 v9, v2, 10, v9
    v_add_u32 v41, 131072, v9
    v_add_u32 v45, s51, v9
    v_add_u32 v17, 0x10000, v45
    v_add_u32 v9, 8, v3
    v_xor_b32 v9, v9, v8
    v_lshlrev_b32 v9, 4, v9
    v_lshl_add_u32 v9, v2, 10, v9
    v_add_u32 v42, 131072, v9
    v_add_u32 v46, s51, v9
    v_add_u32 v18, 0x10000, v46
    v_add_u32 v9, 12, v3
    v_xor_b32 v9, v9, v8
    v_lshlrev_b32 v9, 4, v9
    v_lshl_add_u32 v9, v2, 10, v9
    v_add_u32 v43, 131072, v9
    v_add_u32 v47, s51, v9
    v_add_u32 v19, 0x10000, v47
    s_and_b32 s53, s48, 1
    s_lshr_b32 s54, s48, 1
    s_lshl_b32 s51, s53, 20
    s_lshl_b32 s52, s54, 13
    s_add_u32 s51, s51, s52
    s_lshl_b32 s52, s33, 12
    s_add_u32 s51, s51, s52
    s_lshl_b32 s52, s35, 11
    s_add_u32 s51, s51, s52
    s_add_u32 s51, s51, 36864
    v_add_u32 v48, s51, v7
    v_add_u32 v49, 262144, v48
    v_add_u32 v50, 524288, v48
    v_add_u32 v51, 786432, v48
    v_lshrrev_b32 v8, 1, v1
    v_and_b32 v10, 1, v1
    s_lshl_b32 s51, s48, 2
    s_add_u32 s51, s51, 0
    s_and_b32 s52, s51, 7
    s_lshl_b32 s52, s52, 1
    v_xor_b32 v9, s52, v8
    v_lshlrev_b32 v9, 4, v9
    v_lshl_add_u32 v9, v10, 3, v9
    s_lshl_b32 s51, s51, 10
    s_add_u32 s51, s51, 131072
    v_add_u32 v52, s51, v9
    s_lshl_b32 s51, s48, 2
    s_add_u32 s51, s51, 1
    s_and_b32 s52, s51, 7
    s_lshl_b32 s52, s52, 1
    v_xor_b32 v9, s52, v8
    v_lshlrev_b32 v9, 4, v9
    v_lshl_add_u32 v9, v10, 3, v9
    s_lshl_b32 s51, s51, 10
    s_add_u32 s51, s51, 131072
    v_add_u32 v53, s51, v9
    s_lshl_b32 s51, s48, 2
    s_add_u32 s51, s51, 2
    s_and_b32 s52, s51, 7
    s_lshl_b32 s52, s52, 1
    v_xor_b32 v9, s52, v8
    v_lshlrev_b32 v9, 4, v9
    v_lshl_add_u32 v9, v10, 3, v9
    s_lshl_b32 s51, s51, 10
    s_add_u32 s51, s51, 131072
    v_add_u32 v54, s51, v9
    s_lshl_b32 s51, s48, 2
    s_add_u32 s51, s51, 3
    s_and_b32 s52, s51, 7
    s_lshl_b32 s52, s52, 1
    v_xor_b32 v9, s52, v8
    v_lshlrev_b32 v9, 4, v9
    v_lshl_add_u32 v9, v10, 3, v9
    s_lshl_b32 s51, s51, 10
    s_add_u32 s51, s51, 131072
    v_add_u32 v55, s51, v9
    s_lshl_b32 s51, s48, 2
    v_lshrrev_b32 v8, 2, v2
    v_add_u32 v8, s51, v8
    v_and_b32 v9, 1, v8
    v_lshlrev_b32 v9, 3, v9
    v_and_b32 v10, 3, v2
    v_add_u32 v9, v9, v10
    s_lshl_b32 s51, s35, 2
    v_add_u32 v9, s51, v9
    v_lshrrev_b32 v8, 1, v8
    v_lshlrev_b32 v8, 18, v8
    v_lshl_add_u32 v56, v9, 7, v8
    v_add_u32 v56, 57344, v56
    v_lshlrev_b32 v0, 2, v1
    v_add_u32 v0, 151552, v0
    s_lshl_b32 s51, s48, 8
    v_add_u32 v60, s51, v0
    v_add_u32 v63, 147456, v7
    s_lshl_b32 s51, s48, 10
    v_add_u32 v62, s51, v63
    v_mov_b32 v36, s58
    v_not_b32 v37, s58
L_wf_20:
    ds_read_b32 v8, v6 offset:0
    s_sub_u32 s50, s50, 1
    s_cbranch_scc1 L_end
    s_sleep 1
    s_waitcnt lgkmcnt(0)
    v_cmp_gt_i32 vcc, 112, v8
    s_cbranch_vccnz L_wf_20
    s_branch L_h2_first
L_h2:
    s_mov_b64 exec, 0xffff
L_sn_21:
    global_load_dword v13, v56, s[28:29] sc1
    s_sub_u32 s50, s50, 1
    s_cbranch_scc1 L_end
    s_waitcnt vmcnt(0)
    v_cmp_ne_u32 vcc, s58, v13
    s_cbranch_vccnz L_sn_21
    s_mov_b64 exec, -1
L_h2_first:
    global_load_dwordx4 v[64:67], v48, s[28:29] sc1
    global_load_dwordx4 v[68:71], v48, s[28:29] offset:1024 sc1
    global_load_dwordx4 v[72:75], v49, s[28:29] sc1
    global_load_dwordx4 v[76:79], v49, s[28:29] offset:1024 sc1
    global_load_dwordx4 v[80:83], v50, s[28:29] sc1
    global_load_dwordx4 v[84:87], v50, s[28:29] offset:1024 sc1
    global_load_dwordx4 v[88:91], v51, s[28:29] sc1
    global_load_dwordx4 v[92:95], v51, s[28:29] offset:1024 sc1
    global_load_dwordx2 v[34:35], v59, s[28:29] sc1
    ds_read_b128 v[96:99], v44 offset:0
    ds_read_b128 v[100:103], v45 offset:0
    ds_read_b128 v[104:107], v46 offset:0
    ds_read_b128 v[108:111], v47 offset:0
    ds_read_b128 v[112:115], v44 offset:256
    ds_read_b128 v[116:119], v45 offset:256
    ds_read_b128 v[120:123], v46 offset:256
    ds_read_b128 v[124:127], v47 offset:256
    ds_read_b128 v[128:131], v44 offset:512
    ds_read_b128 v[132:135], v45 offset:512
    ds_read_b128 v[136:139], v46 offset:512
    ds_read_b128 v[140:143], v47 offset:512
    ds_read_b128 v[144:147], v44 offset:768
    ds_read_b128 v[148:151], v45 offset:768
    ds_read_b128 v[152:155], v46 offset:768
    ds_read_b128 v[156:159], v47 offset:768
L_wf_22:
    ds_read_b32 v8, v6 offset:0
    s_sub_u32 s50, s50, 1
    s_cbranch_scc1 L_end
    s_waitcnt lgkmcnt(0)
    v_cmp_gt_i32 vcc, 128, v8
    s_cbranch_vccnz L_wf_22
    ds_read_b128 v[160:163], v16 offset:0
    ds_read_b128 v[164:167], v17 offset:0
    ds_read_b128 v[168:171], v18 offset:0
    ds_read_b128 v[172:175], v19 offset:0
    ds_read_b128 v[176:179], v16 offset:256
    ds_read_b128 v[180:183], v17 offset:256
    ds_read_b128 v[184:187], v18 offset:256
    ds_read_b128 v[188:191], v19 offset:256
    ds_read_b128 v[192:195], v16 offset:512
    ds_read_b128 v[196:199], v17 offset:512
    ds_read_b128 v[200:203], v18 offset:512
    ds_read_b128 v[204:207], v19 offset:512
    ds_read_b128 v[208:211], v16 offset:768
    ds_read_b128 v[212:215], v17 offset:768
    ds_read_b128 v[216:219], v18 offset:768
    ds_read_b128 v[220:223], v19 offset:768
    v_mov_b32 v32, 0
    s_waitcnt vmcnt(8)
    ds_write_b64 v52, v[64:65] offset:0
    v_bitop3_b32 v32, v66, v36, v32 bitop3:0xbe
    v_bitop3_b32 v32, v67, v37, v32 bitop3:0xbe
    s_waitcnt vmcnt(7)
    ds_write_b64 v52, v[68:69] offset:512
    v_bitop3_b32 v32, v70, v36, v32 bitop3:0xbe
    v_bitop3_b32 v32, v71, v37, v32 bitop3:0xbe
    s_waitcnt vmcnt(6)
    ds_write_b64 v53, v[72:73] offset:0
    v_bitop3_b32 v32, v74, v36, v32 bitop3:0xbe
    v_bitop3_b32 v32, v75, v37, v32 bitop3:0xbe
    s_waitcnt vmcnt(5)
    ds_write_b64 v53, v[76:77] offset:512
    v_bitop3_b32 v32, v78, v36, v32 bitop3:0xbe
    v_bitop3_b32 v32, v79, v37, v32 bitop3:0xbe
    s_waitcnt vmcnt(4)
    ds_write_b64 v54, v[80:81] offset:0
    v_bitop3_b32 v32, v82, v36, v32 bitop3:0xbe
    v_bitop3_b32 v32, v83, v37, v32 bitop3:0xbe
    s_waitcnt vmcnt(3)
    ds_write_b64 v54, v[84:85] offset:512
    v_bitop3_b32 v32, v86, v36, v32 bitop3:0xbe
    v_bitop3_b32 v32, v87, v37, v32 bitop3:0xbe
    s_waitcnt vmcnt(2)
    ds_write_b64 v55, v[88:89] offset:0
    v_bitop3_b32 v32, v90, v36, v32 bitop3:0xbe
    v_bitop3_b32 v32, v91, v37, v32 bitop3:0xbe
    s_waitcnt vmcnt(1)
    ds_write_b64 v55, v[92:93] offset:512
    v_bitop3_b32 v32, v94, v36, v32 bitop3:0xbe
    v_bitop3_b32 v32, v95, v37, v32 bitop3:0xbe
    v_cmp_ne_u32 vcc, 0, v32
    s_cbranch_vccnz L_h2
    v_mov_b32 v12, 1
    ds_write_b32 v5, v12
    v_and_b32 v10, 7, v26
    v_lshl_add_u32 v9, v26, 10, v27
    s_lshl_b32 s51, s48, 8
    v_add_u32 v9, s51, v9
L_wf_23:
    ds_read_b32 v8, v14 offset:0
    ds_read_b128 v[224:227], v40 offset:0
    ds_read_b128 v[228:231], v41 offset:0
    ds_read_b128 v[232:235], v42 offset:0
    ds_read_b128 v[236:239], v43 offset:0
    ds_read_b128 v[240:243], v40 offset:256
    ds_read_b128 v[244:247], v41 offset:256
    ds_read_b128 v[248:251], v42 offset:256
    ds_read_b128 v[252:255], v43 offset:256
    s_sub_u32 s50, s50, 1
    s_cbranch_scc1 L_end
    s_waitcnt lgkmcnt(8)
    v_cmp_gt_i32 vcc, 1, v8
    s_cbranch_vccnz L_wf_23
    ds_read_b128 v[64:67], v40 offset:512
    ds_read_b128 v[68:71], v41 offset:512
    ds_read_b128 v[72:75], v42 offset:512
    ds_read_b128 v[76:79], v43 offset:512
    ds_read_b128 v[80:83], v40 offset:768
    ds_read_b128 v[84:87], v41 offset:768
    ds_read_b128 v[88:91], v42 offset:768
    ds_read_b128 v[92:95], v43 offset:768
    s_waitcnt vmcnt(0)
    v_xor_b32 v34, s58, v34
    v_xor_b32 v35, s101, v35
    v_or_b32 v34, v34, v35
    v_cmp_ne_u32 vcc, 0, v34
    s_cmp_eq_u64 vcc, 0
    s_cselect_b32 s101, 1, 0
    s_waitcnt lgkmcnt(15)
    v_mfma_f32_16x16x32_bf16 v[32:35], v[96:99], v[224:227], 0
    v_xor_b32 v11, 0, v10
    v_lshl_add_u32 v44, v11, 5, v9
    v_mfma_f32_16x16x32_bf16 v[36:39], v[160:163], v[224:227], 0
    v_xor_b32 v11, 1, v10
    s_waitcnt lgkmcnt(14)
    v_mfma_f32_16x16x32_bf16 v[32:35], v[100:103], v[228:231], v[32:35]
    v_lshl_add_u32 v45, v11, 5, v9
    v_xor_b32 v11, 2, v10
    v_mfma_f32_16x16x32_bf16 v[36:39], v[164:167], v[228:231], v[36:39]
    v_lshl_add_u32 v46, v11, 5, v9
    s_waitcnt lgkmcnt(13)
    v_mfma_f32_16x16x32_bf16 v[32:35], v[104:107], v[232:235], v[32:35]
    v_xor_b32 v11, 3, v10
    v_lshl_add_u32 v47, v11, 5, v9
    v_mfma_f32_16x16x32_bf16 v[36:39], v[168:171], v[232:235], v[36:39]
    v_xor_b32 v11, 4, v10
    s_waitcnt lgkmcnt(12)
    v_mfma_f32_16x16x32_bf16 v[32:35], v[108:111], v[236:239], v[32:35]
    v_lshl_add_u32 v48, v11, 5, v9
    v_xor_b32 v11, 5, v10
    v_mfma_f32_16x16x32_bf16 v[36:39], v[172:175], v[236:239], v[36:39]
    v_lshl_add_u32 v49, v11, 5, v9
    s_waitcnt lgkmcnt(11)
    v_mfma_f32_16x16x32_bf16 v[32:35], v[112:115], v[240:243], v[32:35]
    v_xor_b32 v11, 6, v10
    v_lshl_add_u32 v50, v11, 5, v9
    v_mfma_f32_16x16x32_bf16 v[36:39], v[176:179], v[240:243], v[36:39]
    v_xor_b32 v11, 7, v10
    s_waitcnt lgkmcnt(10)
    v_mfma_f32_16x16x32_bf16 v[32:35], v[116:119], v[244:247], v[32:35]
    v_lshl_add_u32 v51, v11, 5, v9
    v_add_u32 v16, 0x10000, v44
    v_mfma_f32_16x16x32_bf16 v[36:39], v[180:183], v[244:247], v[36:39]
    v_add_u32 v17, 0x10000, v45
    s_waitcnt lgkmcnt(9)
    v_mfma_f32_16x16x32_bf16 v[32:35], v[120:123], v[248:251], v[32:35]
    v_add_u32 v18, 0x10000, v46
    v_add_u32 v19, 0x10000, v47
    v_mfma_f32_16x16x32_bf16 v[36:39], v[184:187], v[248:251], v[36:39]
    v_add_u32 v52, 0x10000, v48
    s_waitcnt lgkmcnt(8)
    v_mfma_f32_16x16x32_bf16 v[32:35], v[124:127], v[252:255], v[32:35]
    v_add_u32 v53, 0x10000, v49
    v_add_u32 v54, 0x10000, v50
    v_mfma_f32_16x16x32_bf16 v[36:39], v[188:191], v[252:255], v[36:39]
    v_add_u32 v55, 0x10000, v51
    s_waitcnt lgkmcnt(0)
    v_mfma_f32_16x16x32_bf16 v[32:35], v[128:131], v[64:67], v[32:35]
    ds_read_b64_tr_b16 v[96:97], v44 offset:0
    ds_read_b64_tr_b16 v[98:99], v16 offset:0
    v_mfma_f32_16x16x32_bf16 v[36:39], v[192:195], v[64:67], v[36:39]
    ds_read_b64_tr_b16 v[160:161], v44 offset:16384
    ds_read_b64_tr_b16 v[162:163], v16 offset:16384
    v_mfma_f32_16x16x32_bf16 v[32:35], v[132:135], v[68:71], v[32:35]
    ds_read_b64_tr_b16 v[100:101], v44 offset:32768
    ds_read_b64_tr_b16 v[102:103], v16 offset:32768
    v_mfma_f32_16x16x32_bf16 v[36:39], v[196:199], v[68:71], v[36:39]
    ds_read_b64_tr_b16 v[164:165], v44 offset:49152
    ds_read_b64_tr_b16 v[166:167], v16 offset:49152
    v_mfma_f32_16x16x32_bf16 v[32:35], v[136:139], v[72:75], v[32:35]
    ds_read_b64_tr_b16 v[104:105], v45 offset:0
    ds_read_b64_tr_b16 v[106:107], v17 offset:0
    v_mfma_f32_16x16x32_bf16 v[36:39], v[200:203], v[72:75], v[36:39]
    ds_read_b64_tr_b16 v[168:169], v45 offset:16384
    ds_read_b64_tr_b16 v[170:171], v17 offset:16384
    v_mfma_f32_16x16x32_bf16 v[32:35], v[140:143], v[76:79], v[32:35]
    ds_read_b64_tr_b16 v[108:109], v45 offset:32768
    ds_read_b64_tr_b16 v[110:111], v17 offset:32768
    v_mfma_f32_16x16x32_bf16 v[36:39], v[204:207], v[76:79], v[36:39]
    ds_read_b64_tr_b16 v[172:173], v45 offset:49152
    ds_read_b64_tr_b16 v[174:175], v17 offset:49152
    v_mfma_f32_16x16x32_bf16 v[32:35], v[144:147], v[80:83], v[32:35]
    ds_read_b64_tr_b16 v[112:113], v46 offset:0
    ds_read_b64_tr_b16 v[114:115], v18 offset:0
    v_mfma_f32_16x16x32_bf16 v[36:39], v[208:211], v[80:83], v[36:39]
    ds_read_b64_tr_b16 v[176:177], v46 offset:16384
    ds_read_b64_tr_b16 v[178:179], v18 offset:16384
    v_mfma_f32_16x16x32_bf16 v[32:35], v[148:151], v[84:87], v[32:35]
    ds_read_b64_tr_b16 v[116:117], v46 offset:32768
    ds_read_b64_tr_b16 v[118:119], v18 offset:32768
    v_mfma_f32_16x16x32_bf16 v[36:39], v[212:215], v[84:87], v[36:39]
    ds_read_b64_tr_b16 v[180:181], v46 offset:49152
    ds_read_b64_tr_b16 v[182:183], v18 offset:49152
    v_mfma_f32_16x16x32_bf16 v[32:35], v[152:155], v[88:91], v[32:35]
    ds_read_b64_tr_b16 v[120:121], v47 offset:0
    ds_read_b64_tr_b16 v[122:123], v19 offset:0
    v_mfma_f32_16x16x32_bf16 v[36:39], v[216:219], v[88:91], v[36:39]
    ds_read_b64_tr_b16 v[184:185], v47 offset:16384
    ds_read_b64_tr_b16 v[186:187], v19 offset:16384
    v_mfma_f32_16x16x32_bf16 v[32:35], v[156:159], v[92:95], v[32:35]
    ds_read_b64_tr_b16 v[124:125], v47 offset:32768
    ds_read_b64_tr_b16 v[126:127], v19 offset:32768
    v_mfma_f32_16x16x32_bf16 v[36:39], v[220:223], v[92:95], v[36:39]
    ds_read_b64_tr_b16 v[188:189], v47 offset:49152
    ds_read_b64_tr_b16 v[190:191], v19 offset:49152
    ds_read_b64_tr_b16 v[128:129], v48 offset:0
    ds_read_b64_tr_b16 v[130:131], v52 offset:0
    ds_read_b64_tr_b16 v[192:193], v48 offset:16384
    ds_read_b64_tr_b16 v[194:195], v52 offset:16384
    ds_read_b64_tr_b16 v[132:133], v48 offset:32768
    ds_read_b64_tr_b16 v[134:135], v52 offset:32768
    v_bfi_b32 v64, s39, v4, v32
    v_bfi_b32 v65, s39, v4, v33
    v_bfi_b32 v66, s39, v4, v34
    v_bfi_b32 v67, s39, v4, v35
    v_bfi_b32 v68, s39, v4, v36
    v_bfi_b32 v69, s39, v4, v37
    v_bfi_b32 v70, s39, v4, v38
    v_bfi_b32 v71, s39, v4, v39
    s_cmp_lg_u32 s101, 0
    s_cbranch_scc1 L_sxl
    global_store_dwordx4 v57, v[64:67], s[28:29] sc1
    global_store_dwordx4 v57, v[68:71], s[28:29] offset:1024 sc1
    s_branch L_sxd
L_sxl:
    global_store_dwordx4 v57, v[64:67], s[28:29]
    global_store_dwordx4 v57, v[68:71], s[28:29] offset:1024
L_sxd:
    ds_read_b64_tr_b16 v[196:197], v48 offset:49152
    ds_read_b64_tr_b16 v[198:199], v52 offset:49152
    ds_read_b64_tr_b16 v[136:137], v49 offset:0
    ds_read_b64_tr_b16 v[138:139], v53 offset:0
    ds_read_b64_tr_b16 v[200:201], v49 offset:16384
    ds_read_b64_tr_b16 v[202:203], v53 offset:16384
    ds_read_b64_tr_b16 v[140:141], v49 offset:32768
    ds_read_b64_tr_b16 v[142:143], v53 offset:32768
    ds_read_b64_tr_b16 v[204:205], v49 offset:49152
    ds_read_b64_tr_b16 v[206:207], v53 offset:49152
    ds_read_b64_tr_b16 v[144:145], v50 offset:0
    ds_read_b64_tr_b16 v[146:147], v54 offset:0
    ds_read_b64_tr_b16 v[208:209], v50 offset:16384
    ds_read_b64_tr_b16 v[210:211], v54 offset:16384
    ds_read_b64_tr_b16 v[148:149], v50 offset:32768
    ds_read_b64_tr_b16 v[150:151], v54 offset:32768
    ds_read_b64_tr_b16 v[212:213], v50 offset:49152
    ds_read_b64_tr_b16 v[214:215], v54 offset:49152
    ds_read_b64_tr_b16 v[152:153], v51 offset:0
    ds_read_b64_tr_b16 v[154:155], v55 offset:0
    ds_read_b64_tr_b16 v[216:217], v51 offset:16384
    ds_read_b64_tr_b16 v[218:219], v55 offset:16384
    ds_read_b64_tr_b16 v[156:157], v51 offset:32768
    ds_read_b64_tr_b16 v[158:159], v55 offset:32768
    ds_read_b64_tr_b16 v[220:221], v51 offset:49152
    ds_read_b64_tr_b16 v[222:223], v55 offset:49152
L_h25_24_f:
    global_load_dwordx4 v[72:75], v58, s[28:29] sc1
    global_load_dwordx4 v[76:79], v58, s[28:29] offset:1024 sc1
    s_waitcnt vmcnt(0)
    v_xor_b32 v72, v72, v4
    v_xor_b32 v73, v73, v4
    v_xor_b32 v74, v74, v4
    v_xor_b32 v75, v75, v4
    v_xor_b32 v76, v76, v4
    v_xor_b32 v77, v77, v4
    v_xor_b32 v78, v78, v4
    v_xor_b32 v79, v79, v4
    v_or3_b32 v16, v72, v73, v74
    v_or3_b32 v16, v16, v75, v76
    v_or3_b32 v16, v16, v77, v78
    v_or_b32 v16, v16, v79
    v_and_b32 v16, s39, v16
    v_cmp_ne_u32 vcc, 0, v16
    s_cbranch_vccnz L_h25_24
    v_pk_add_f32 v[32:33], v[32:33], v[72:73]
    v_pk_add_f32 v[34:35], v[34:35], v[74:75]
    v_pk_add_f32 v[36:37], v[36:37], v[76:77]
    v_pk_add_f32 v[38:39], v[38:39], v[78:79]
    v_max3_f32 v16, v32, v33, v34
    v_max3_f32 v17, v35, v36, v37
    v_max3_f32 v16, v16, v38, v39
    v_max_f32 v16, v16, v17
    v_mul_f32 v16, s59, v16
    v_ceil_f32 v16, v16
    ds_max_f32 v61, v16
    ds_write_b32 v60, v16
    v_fma_f32 v32, v32, s59, -v16
    v_fma_f32 v33, v33, s59, -v16
    v_fma_f32 v34, v34, s59, -v16
    v_fma_f32 v35, v35, s59, -v16
    v_fma_f32 v36, v36, s59, -v16
    v_fma_f32 v37, v37, s59, -v16
    v_fma_f32 v38, v38, s59, -v16
    v_fma_f32 v39, v39, s59, -v16
    v_exp_f32 v32, v32
    v_exp_f32 v33, v33
    v_exp_f32 v34, v34
    v_exp_f32 v35, v35
    v_exp_f32 v36, v36
    v_exp_f32 v37, v37
    v_exp_f32 v38, v38
    v_exp_f32 v39, v39
    v_cvt_pk_bf16_f32 v64, v32, v33
    v_cvt_pk_bf16_f32 v65, v34, v35
    v_cvt_pk_bf16_f32 v66, v36, v37
    v_cvt_pk_bf16_f32 v67, v38, v39
    ds_write_b128 v62, v[64:67]
    v_mov_b32 v12, 2
    ds_write_b32 v5, v12
L_wf_25:
    ds_read_b32 v8, v14 offset:0
    ds_read_b32 v32, v61
    ds_read2st64_b32 v[16:17], v0 offset0:0 offset1:1
    ds_read2st64_b32 v[18:19], v0 offset0:2 offset1:3
    ds_read_b128 v[72:75], v63 offset:0
    ds_read_b128 v[76:79], v63 offset:1024
    ds_read_b128 v[80:83], v63 offset:2048
    ds_read_b128 v[84:87], v63 offset:3072
    s_sub_u32 s50, s50, 1
    s_cbranch_scc1 L_end
    s_waitcnt lgkmcnt(7)
    v_cmp_gt_i32 vcc, 2, v8
    s_cbranch_vccnz L_wf_25
    s_waitcnt lgkmcnt(3)
    v_sub_f32 v16, v32, v16
    v_min_f32 v16, 0x437f0000, v16
    v_cvt_u32_f32 v16, v16
    v_mul_u32_u24 v16, 0x800080, v16
    v_pk_sub_u16 v72, v72, v16 clamp
    v_pk_sub_u16 v73, v73, v16 clamp
    v_pk_sub_u16 v74, v74, v16 clamp
    v_pk_sub_u16 v75, v75, v16 clamp
    s_mov_b32 s54, 0x00010001
    s_nop 0
    v_mfma_f32_16x16x32_bf16 v[224:227], v[72:75], v[96:99], 0
    s_waitcnt lgkmcnt(0)
    v_sub_f32 v17, v32, v17
    v_min_f32 v17, 0x437f0000, v17
    v_cvt_u32_f32 v17, v17
    v_mfma_f32_16x16x32_bf16 v[228:231], v[72:75], v[104:107], 0
    v_mul_u32_u24 v17, 0x800080, v17
    v_pk_sub_u16 v76, v76, v17 clamp
    v_pk_sub_u16 v77, v77, v17 clamp
    v_mfma_f32_16x16x32_bf16 v[232:235], v[72:75], v[112:115], 0
    v_pk_sub_u16 v78, v78, v17 clamp
    v_pk_sub_u16 v79, v79, v17 clamp
    v_sub_f32 v18, v32, v18
    v_mfma_f32_16x16x32_bf16 v[236:239], v[72:75], v[120:123], 0
    v_min_f32 v18, 0x437f0000, v18
    v_cvt_u32_f32 v18, v18
    v_mul_u32_u24 v18, 0x800080, v18
    v_mfma_f32_16x16x32_bf16 v[240:243], v[72:75], v[128:131], 0
    v_pk_sub_u16 v80, v80, v18 clamp
    v_pk_sub_u16 v81, v81, v18 clamp
    v_pk_sub_u16 v82, v82, v18 clamp
    v_mfma_f32_16x16x32_bf16 v[244:247], v[72:75], v[136:139], 0
    v_pk_sub_u16 v83, v83, v18 clamp
    v_sub_f32 v19, v32, v19
    v_min_f32 v19, 0x437f0000, v19
    v_mfma_f32_16x16x32_bf16 v[248:251], v[72:75], v[144:147], 0
    v_cvt_u32_f32 v19, v19
    v_mul_u32_u24 v19, 0x800080, v19
    v_pk_sub_u16 v84, v84, v19 clamp
    v_mfma_f32_16x16x32_bf16 v[252:255], v[72:75], v[152:155], 0
    v_pk_sub_u16 v85, v85, v19 clamp
    v_pk_sub_u16 v86, v86, v19 clamp
    v_pk_sub_u16 v87, v87, v19 clamp
    v_mfma_f32_16x16x32_bf16 v[224:227], v[76:79], v[160:163], v[224:227]
    v_mfma_f32_16x16x32_bf16 v[228:231], v[76:79], v[168:171], v[228:231]
    v_mfma_f32_16x16x32_bf16 v[224:227], v[80:83], v[100:103], v[224:227]
    v_mfma_f32_16x16x32_bf16 v[228:231], v[80:83], v[108:111], v[228:231]
    v_mfma_f32_16x16x32_bf16 v[224:227], v[84:87], v[164:167], v[224:227]
    v_mfma_f32_16x16x32_bf16 v[228:231], v[84:87], v[172:175], v[228:231]
    v_mfma_f32_16x16x32_bf16 v[232:235], v[76:79], v[176:179], v[232:235]
    v_mfma_f32_16x16x32_bf16 v[236:239], v[76:79], v[184:187], v[236:239]
    v_mfma_f32_16x16x32_bf16 v[232:235], v[80:83], v[116:119], v[232:235]
    v_mfma_f32_16x16x32_bf16 v[236:239], v[80:83], v[124:127], v[236:239]
    s_nop 3
    v_cvt_pk_bf16_f32 v40, v224, v228
    v_cvt_pk_bf16_f32 v44, v225, v229
    v_cvt_pk_bf16_f32 v48, v226, v230
    v_mfma_f32_16x16x32_bf16 v[232:235], v[84:87], v[180:183], v[232:235]
    v_cvt_pk_bf16_f32 v52, v227, v231
    v_bfi_b32 v40, s54, v20, v40
    v_bfi_b32 v44, s54, v20, v44
    v_mfma_f32_16x16x32_bf16 v[236:239], v[84:87], v[188:191], v[236:239]
    v_bfi_b32 v48, s54, v20, v48
    v_bfi_b32 v52, s54, v20, v52
    s_cmp_lg_u32 s48, 1
    s_cbranch_scc1 L_np_26
    v_mov_b32 v8, s58
    s_mov_b64 exec, 15
    global_store_dwordx4 v24, v[8:11], s[28:29] sc1
    s_mov_b64 exec, -1
L_np_26:
    v_mfma_f32_16x16x32_bf16 v[240:243], v[76:79], v[192:195], v[240:243]
    v_mfma_f32_16x16x32_bf16 v[244:247], v[76:79], v[200:203], v[244:247]
    v_mfma_f32_16x16x32_bf16 v[240:243], v[80:83], v[132:135], v[240:243]
    v_mfma_f32_16x16x32_bf16 v[244:247], v[80:83], v[140:143], v[244:247]
    v_cvt_pk_bf16_f32 v41, v232, v236
    v_cvt_pk_bf16_f32 v45, v233, v237
    v_cvt_pk_bf16_f32 v49, v234, v238
    v_mfma_f32_16x16x32_bf16 v[240:243], v[84:87], v[196:199], v[240:243]
    v_cvt_pk_bf16_f32 v53, v235, v239
    v_bfi_b32 v41, s54, v21, v41
    v_bfi_b32 v45, s54, v21, v45
    v_mfma_f32_16x16x32_bf16 v[244:247], v[84:87], v[204:207], v[244:247]
    v_bfi_b32 v49, s54, v21, v49
    v_bfi_b32 v53, s54, v21, v53
    v_mfma_f32_16x16x32_bf16 v[248:251], v[76:79], v[208:211], v[248:251]
    v_mfma_f32_16x16x32_bf16 v[252:255], v[76:79], v[216:219], v[252:255]
    v_mfma_f32_16x16x32_bf16 v[248:251], v[80:83], v[148:151], v[248:251]
    v_mfma_f32_16x16x32_bf16 v[252:255], v[80:83], v[156:159], v[252:255]
    s_nop 1
    v_cvt_pk_bf16_f32 v42, v240, v244
    v_cvt_pk_bf16_f32 v46, v241, v245
    v_cvt_pk_bf16_f32 v50, v242, v246
    v_mfma_f32_16x16x32_bf16 v[248:251], v[84:87], v[212:215], v[248:251]
    v_cvt_pk_bf16_f32 v54, v243, v247
    v_bfi_b32 v42, s54, v22, v42
    v_bfi_b32 v46, s54, v22, v46
    v_mfma_f32_16x16x32_bf16 v[252:255], v[84:87], v[220:223], v[252:255]
    v_bfi_b32 v50, s54, v22, v50
    v_bfi_b32 v54, s54, v22, v54
    s_cmp_lg_u32 s48, 0
    s_cbranch_scc1 L_nol
    v_mov_b32 v16, 0x3f803f80
    v_mov_b32 v17, 0x3f803f80
    v_mov_b32 v18, 0x3f803f80
    v_mov_b32 v19, 0x3f803f80
    s_nop 1
    v_mfma_f32_16x16x32_bf16 v[64:67], v[16:19], v[72:75], 0
    v_mfma_f32_16x16x32_bf16 v[64:67], v[16:19], v[76:79], v[64:67]
    v_mfma_f32_16x16x32_bf16 v[64:67], v[16:19], v[80:83], v[64:67]
    v_mfma_f32_16x16x32_bf16 v[64:67], v[16:19], v[84:87], v[64:67]
L_nol:
    s_nop 3
    v_cvt_pk_bf16_f32 v43, v248, v252
    v_bfi_b32 v43, s54, v23, v43
    global_store_dwordx4 v28, v[40:43], s[28:29] sc1
    v_cvt_pk_bf16_f32 v47, v249, v253
    v_bfi_b32 v47, s54, v23, v47
    global_store_dwordx4 v29, v[44:47], s[28:29] sc1
    v_cvt_pk_bf16_f32 v51, v250, v254
    v_bfi_b32 v51, s54, v23, v51
    global_store_dwordx4 v30, v[48:51], s[28:29] sc1
    v_cvt_pk_bf16_f32 v55, v251, v255
    v_bfi_b32 v55, s54, v23, v55
    global_store_dwordx4 v31, v[52:55], s[28:29] sc1
    s_cmp_lg_u32 s48, 0
    s_cbranch_scc1 L_nost
    v_mov_b32 v33, v64
    v_mov_b32 v34, s58
    v_not_b32 v35, s58
    s_mov_b64 exec, 0xffff
    global_store_dwordx4 v25, v[32:35], s[28:29] sc1
    s_mov_b64 exec, -1
L_nost:
    v_mov_b32 v12, 3
    ds_write_b32 v5, v12
    s_cmp_lt_u32 s46, 56
    s_cbranch_scc0 L_nodown
    s_lshl_b32 s51, s30, 18
    s_lshl_b32 s52, s31, 12
    s_add_u32 s51, s51, s52
    s_add_u32 s51, s51, 67584
    v_add_u32 v80, s51, v7
    v_bfe_u32 v9, v1, 2, 1
    v_lshlrev_b32 v21, 5, v9
    v_lshl_add_u32 v21, v3, 2, v21
    v_add_u32 v22, 16, v21
    v_and_b32 v8, 3, v26
    v_lshl_add_u32 v9, v8, 3, v3
    v_mul_u32_u24 v9, 896, v9
    v_add_u32 v9, v9, v27
    s_mul_i32 s51, s48, 7
    s_add_u32 s51, s51, 0
    v_xor_b32 v10, s51, v8
    v_lshl_add_u32 v232, v10, 5, v9
    s_mul_i32 s51, s48, 7
    s_add_u32 s51, s51, 1
    v_xor_b32 v10, s51, v8
    v_lshl_add_u32 v233, v10, 5, v9
    s_mul_i32 s51, s48, 7
    s_add_u32 s51, s51, 2
    v_xor_b32 v10, s51, v8
    v_lshl_add_u32 v234, v10, 5, v9
    s_mul_i32 s51, s48, 7
    s_add_u32 s51, s51, 3
    v_xor_b32 v10, s51, v8
    v_lshl_add_u32 v235, v10, 5, v9
    s_mul_i32 s51, s48, 7
    s_add_u32 s51, s51, 4
    v_xor_b32 v10, s51, v8
    v_lshl_add_u32 v236, v10, 5, v9
    s_mul_i32 s51, s48, 7
    s_add_u32 s51, s51, 5
    v_xor_b32 v10, s51, v8
    v_lshl_add_u32 v237, v10, 5, v9
    s_mul_i32 s51, s48, 7
    s_add_u32 s51, s51, 6
    v_xor_b32 v10, s51, v8
    v_lshl_add_u32 v238, v10, 5, v9
    v_and_b32 v9, 7, v26
    v_lshlrev_b32 v9, 18, v9
    v_lshl_add_u32 v9, v27, 1, v9
    v_lshrrev_b32 v10, 5, v1
    s_lshl_b32 s51, s48, 13
    s_lshl_b32 s52, s46, 6
    s_add_u32 s51, s51, s52
    s_add_u32 s51, s51, 96256
    v_lshl_add_u32 v24, v10, 12, v9
    v_add_u32 v24, s51, v24
L_hf1_27_f:
    v_mov_b32 v76, v4
    v_mov_b32 v77, v4
    v_mov_b32 v78, v4
    v_mov_b32 v79, v4
    global_load_dwordx4 v[64:67], v80, s[28:29] offset:0 sc1
    global_load_dwordx4 v[68:71], v80, s[28:29] offset:1024 sc1
    global_load_dwordx4 v[72:75], v80, s[28:29] offset:2048 sc1
    s_mov_b32 exec_lo, 0xffffffff
    s_mov_b32 exec_hi, 0x0
    global_load_dwordx4 v[76:79], v80, s[28:29] offset:3072 sc1
    s_mov_b64 exec, -1
    s_waitcnt vmcnt(0)
    v_xor_b32 v64, v64, v4
    v_xor_b32 v65, v65, v4
    v_xor_b32 v66, v66, v4
    v_xor_b32 v67, v67, v4
    v_xor_b32 v68, v68, v4
    v_xor_b32 v69, v69, v4
    v_xor_b32 v70, v70, v4
    v_xor_b32 v71, v71, v4
    v_xor_b32 v72, v72, v4
    v_xor_b32 v73, v73, v4
    v_xor_b32 v74, v74, v4
    v_xor_b32 v75, v75, v4
    v_xor_b32 v76, v76, v4
    v_xor_b32 v77, v77, v4
    v_xor_b32 v78, v78, v4
    v_xor_b32 v79, v79, v4
    v_or3_b32 v48, v64, v65, v66
    v_or3_b32 v48, v48, v67, v68
    v_or3_b32 v48, v48, v69, v70
    v_or3_b32 v48, v48, v71, v72
    v_or3_b32 v48, v48, v73, v74
    v_or3_b32 v48, v48, v75, v76
    v_or3_b32 v48, v48, v77, v78
    v_or_b32 v48, v48, v79
    v_and_b32 v48, s39, v48
    v_cmp_ne_u32 vcc, 0, v48
    s_cbranch_vccnz L_hf1_27
    v_pk_add_f32 v[64:65], v[64:65], v[68:69]
    v_pk_add_f32 v[72:73], v[72:73], v[76:77]
    v_pk_add_f32 v[66:67], v[66:67], v[70:71]
    v_pk_add_f32 v[74:75], v[74:75], v[78:79]
    v_pk_add_f32 v[32:33], v[64:65], v[72:73]
    v_pk_add_f32 v[34:35], v[66:67], v[74:75]
    v_mov_b32 v36, v32
    v_mov_b32 v37, v33
    v_mov_b32 v38, v34
    v_mov_b32 v39, v35
    v_permlane32_swap_b32 v32, v36
    v_permlane32_swap_b32 v33, v37
    v_permlane32_swap_b32 v34, v38
    v_permlane32_swap_b32 v35, v39
    v_add_f32 v32, v32, v36
    v_add_f32 v33, v33, v37
    v_add_f32 v34, v34, v38
    v_add_f32 v35, v35, v39
    v_mov_b32 v36, v32
    v_mov_b32 v37, v33
    v_mov_b32 v38, v34
    v_mov_b32 v39, v35
    v_permlane16_swap_b32 v32, v36
    v_permlane16_swap_b32 v33, v37
    v_permlane16_swap_b32 v34, v38
    v_permlane16_swap_b32 v35, v39
    v_cvt_pk_bf16_f32 v32, v32, v32
    v_and_b32 v32, 0xffff0000, v32
    v_cvt_pk_bf16_f32 v33, v33, v33
    v_and_b32 v33, 0xffff0000, v33
    v_cvt_pk_bf16_f32 v34, v34, v34
    v_and_b32 v34, 0xffff0000, v34
    v_cvt_pk_bf16_f32 v35, v35, v35
    v_and_b32 v35, 0xffff0000, v35
    v_cvt_pk_bf16_f32 v36, v36, v36
    v_and_b32 v36, 0xffff0000, v36
    v_cvt_pk_bf16_f32 v37, v37, v37
    v_and_b32 v37, 0xffff0000, v37
    v_cvt_pk_bf16_f32 v38, v38, v38
    v_and_b32 v38, 0xffff0000, v38
    v_cvt_pk_bf16_f32 v39, v39, v39
    v_and_b32 v39, 0xffff0000, v39
    s_mov_b32 s51, 0x3d372713
    v_mul_f32 v40, v32, v32
    v_mul_f32 v41, v33, v33
    v_mul_f32 v42, v34, v34
    v_mul_f32 v43, v35, v35
    v_fma_f32 v40, v40, s51, 1.0
    v_fma_f32 v41, v41, s51, 1.0
    v_fma_f32 v42, v42, s51, 1.0
    v_fma_f32 v43, v43, s51, 1.0
    v_mul_f32 v40, v40, v32
    v_mul_f32 v41, v41, v33
    v_mul_f32 v42, v42, v34
    v_mul_f32 v43, v43, v35
    v_mul_f32 v40, 0xc0135761, v40
    v_mul_f32 v41, 0xc0135761, v41
    v_mul_f32 v42, 0xc0135761, v42
    v_mul_f32 v43, 0xc0135761, v43
    v_exp_f32 v40, v40
    v_exp_f32 v41, v41
    v_exp_f32 v42, v42
    v_exp_f32 v43, v43
    v_add_f32 v40, 1.0, v40
    v_add_f32 v41, 1.0, v41
    v_add_f32 v42, 1.0, v42
    v_add_f32 v43, 1.0, v43
    v_rcp_f32 v40, v40
    v_rcp_f32 v41, v41
    v_rcp_f32 v42, v42
    v_rcp_f32 v43, v43
    v_mul_f32 v40, v40, v32
    v_mul_f32 v41, v41, v33
    v_mul_f32 v42, v42, v34
    v_mul_f32 v43, v43, v35
    v_cvt_pk_bf16_f32 v40, v40, v40
    v_and_b32 v40, 0xffff0000, v40
    v_cvt_pk_bf16_f32 v41, v41, v41
    v_and_b32 v41, 0xffff0000, v41
    v_cvt_pk_bf16_f32 v42, v42, v42
    v_and_b32 v42, 0xffff0000, v42
    v_cvt_pk_bf16_f32 v43, v43, v43
    v_and_b32 v43, 0xffff0000, v43
    v_mul_f32 v40, v40, v36
    v_mul_f32 v41, v41, v37
    v_mul_f32 v42, v42, v38
    v_mul_f32 v43, v43, v39
    v_cvt_pk_bf16_f32 v32, v40, v41
    v_cvt_pk_bf16_f32 v33, v42, v43
    ds_bpermute_b32 v36, v21, v32
    ds_bpermute_b32 v37, v21, v33
    ds_bpermute_b32 v38, v22, v32
    ds_bpermute_b32 v39, v22, v33
L_wf_28:
    ds_read_b32 v8, v6 offset:0
    s_sub_u32 s50, s50, 1
    s_cbranch_scc1 L_end
    s_waitcnt lgkmcnt(0)
    v_cmp_gt_i32 vcc, 156, v8
    s_cbranch_vccnz L_wf_28
    ds_read_b64_tr_b16 v[96:97], v232 offset:0
    ds_read_b64_tr_b16 v[98:99], v232 offset:3584
    ds_read_b64_tr_b16 v[100:101], v233 offset:0
    ds_read_b64_tr_b16 v[102:103], v233 offset:3584
    ds_read_b64_tr_b16 v[104:105], v234 offset:0
    ds_read_b64_tr_b16 v[106:107], v234 offset:3584
    ds_read_b64_tr_b16 v[108:109], v235 offset:0
    ds_read_b64_tr_b16 v[110:111], v235 offset:3584
    ds_read_b64_tr_b16 v[112:113], v236 offset:0
    ds_read_b64_tr_b16 v[114:115], v236 offset:3584
    ds_read_b64_tr_b16 v[116:117], v237 offset:0
    ds_read_b64_tr_b16 v[118:119], v237 offset:3584
    ds_read_b64_tr_b16 v[120:121], v238 offset:0
    ds_read_b64_tr_b16 v[122:123], v238 offset:3584
    s_waitcnt lgkmcnt(0)
    v_mfma_f32_16x16x32_bf16 v[160:163], v[36:39], v[96:99], 0
    v_mfma_f32_16x16x32_bf16 v[164:167], v[36:39], v[100:103], 0
    v_mfma_f32_16x16x32_bf16 v[168:171], v[36:39], v[104:107], 0
    v_mfma_f32_16x16x32_bf16 v[172:175], v[36:39], v[108:111], 0
    v_mfma_f32_16x16x32_bf16 v[176:179], v[36:39], v[112:115], 0
    v_mfma_f32_16x16x32_bf16 v[180:183], v[36:39], v[116:119], 0
    v_mfma_f32_16x16x32_bf16 v[184:187], v[36:39], v[120:123], 0
    s_nop 1
    v_bfi_b32 v56, s39, v4, v160
    v_bfi_b32 v57, s39, v4, v164
    v_bfi_b32 v58, s39, v4, v168
    v_bfi_b32 v59, s39, v4, v172
    s_mov_b32 exec_lo, 0
    v_bfi_b32 v56, s39, v4, v176
    v_bfi_b32 v57, s39, v4, v180
    v_bfi_b32 v58, s39, v4, v184
    s_mov_b32 exec_lo, -1
    global_store_dwordx4 v24, v[56:59], s[28:29] sc1
L_nodown:
    s_endpgm
L_h25_24:
    s_sub_u32 s50, s50, 1
    s_cbranch_scc1 L_end
    s_branch L_h25_24_f
L_hf1_27:
    s_sub_u32 s50, s50, 1
    s_cbranch_scc1 L_end
    s_sleep 4
    s_branch L_hf1_27_f
L_loader2b:
    v_xor_b32 v8, 0, v7
    v_add_u32 v20, 0, v8
    v_xor_b32 v8, 32, v7
    v_add_u32 v21, 2048, v8
    v_xor_b32 v8, 64, v7
    v_add_u32 v22, 4096, v8
    v_xor_b32 v8, 96, v7
    v_add_u32 v23, 6144, v8
    v_xor_b32 v8, 128, v7
    v_add_u32 v24, 8192, v8
    v_xor_b32 v8, 160, v7
    v_add_u32 v25, 10240, v8
    v_xor_b32 v8, 192, v7
    v_add_u32 v26, 12288, v8
    v_xor_b32 v8, 224, v7
    v_add_u32 v27, 14336, v8
    s_mov_b32 s40, s6
    s_mov_b32 s41, s7
    s_mov_b32 s42, 16777216
    s_lshl_b32 s44, s30, 21
    s_lshr_b32 s51, s31, 1
    s_lshl_b32 s51, s51, 18
    s_add_u32 s44, s44, s51
    s_and_b32 s51, s31, 1
    s_lshl_b32 s51, s51, 10
    s_add_u32 s44, s44, s51
    s_mov_b32 m0, 0
    v_mov_b32 v18, -4
    s_mov_b32 s45, 2
L_ld_29:
    buffer_load_dwordx4 v20, s[40:43], s44 offen nt lds
    s_add_u32 m0, m0, 1024
    s_nop 0
    buffer_load_dwordx4 v21, s[40:43], s44 offen nt lds
    s_add_u32 m0, m0, 1024
    s_nop 0
    buffer_load_dwordx4 v22, s[40:43], s44 offen nt lds
    s_add_u32 m0, m0, 1024
    s_nop 0
    buffer_load_dwordx4 v23, s[40:43], s44 offen nt lds
    s_add_u32 m0, m0, 1024
    v_add_u32 v18, 4, v18
    v_max_i32 v19, v19, v18
    s_waitcnt vmcnt(4)
    ds_write_b32 v6, v19
    buffer_load_dwordx4 v24, s[40:43], s44 offen nt lds
    s_add_u32 m0, m0, 1024
    s_nop 0
    buffer_load_dwordx4 v25, s[40:43], s44 offen nt lds
    s_add_u32 m0, m0, 1024
    s_nop 0
    buffer_load_dwordx4 v26, s[40:43], s44 offen nt lds
    s_add_u32 m0, m0, 1024
    s_nop 0
    buffer_load_dwordx4 v27, s[40:43], s44 offen nt lds
    s_add_u32 m0, m0, 1024
    s_add_u32 s44, s44, 16384
    v_add_u32 v18, 4, v18
    v_max_i32 v19, v19, v18
    s_waitcnt vmcnt(4)
    ds_write_b32 v6, v19
    s_sub_u32 s45, s45, 1
    s_cmp_lg_u32 s45, 0
    s_cbranch_scc1 L_ld_29
    v_subrev_u32 v18, 36, v18
    s_mov_b32 s45, 8
L_ld_30:
    buffer_load_dwordx4 v20, s[40:43], s44 offen nt lds
    s_add_u32 m0, m0, 1024
    s_nop 0
    buffer_load_dwordx4 v21, s[40:43], s44 offen nt lds
    s_add_u32 m0, m0, 1024
    s_nop 0
    buffer_load_dwordx4 v22, s[40:43], s44 offen nt lds
    s_add_u32 m0, m0, 1024
    s_nop 0
    buffer_load_dwordx4 v23, s[40:43], s44 offen nt lds
    s_add_u32 m0, m0, 1024
    v_add_u32 v18, 4, v18
    v_max_i32 v19, v19, v18
    s_waitcnt vmcnt(40)
    ds_write_b32 v6, v19
    buffer_load_dwordx4 v24, s[40:43], s44 offen nt lds
    s_add_u32 m0, m0, 1024
    s_nop 0
    buffer_load_dwordx4 v25, s[40:43], s44 offen nt lds
    s_add_u32 m0, m0, 1024
    s_nop 0
    buffer_load_dwordx4 v26, s[40:43], s44 offen nt lds
    s_add_u32 m0, m0, 1024
    s_nop 0
    buffer_load_dwordx4 v27, s[40:43], s44 offen nt lds
    s_add_u32 m0, m0, 1024
    s_add_u32 s44, s44, 16384
    v_add_u32 v18, 4, v18
    v_max_i32 v19, v19, v18
    s_waitcnt vmcnt(40)
    ds_write_b32 v6, v19
    s_sub_u32 s45, s45, 1
    s_cmp_lg_u32 s45, 0
    s_cbranch_scc1 L_ld_30
    s_waitcnt lgkmcnt(0)
    s_add_u32 s58, s55, 1
    s_and_b32 s38, s58, 0xfff
    v_mov_b32 v4, s38
    s_lshl_b32 s51, s30, 18
    s_lshl_b32 s52, s31, 7
    s_add_u32 s51, s51, s52
    s_add_u32 s51, s51, 65536
    v_add_u32 v13, s51, v7
    v_mov_b32 v8, s58
    s_mov_b64 exec, 15
    global_store_dwordx4 v13, v[8:11], s[28:29] sc1
    s_mov_b64 exec, -1
    s_mov_b32 s45, 6
L_ld_31:
    buffer_load_dwordx4 v20, s[40:43], s44 offen nt lds
    s_add_u32 m0, m0, 1024
    s_nop 0
    buffer_load_dwordx4 v21, s[40:43], s44 offen nt lds
    s_add_u32 m0, m0, 1024
    s_nop 0
    buffer_load_dwordx4 v22, s[40:43], s44 offen nt lds
    s_add_u32 m0, m0, 1024
    s_nop 0
    buffer_load_dwordx4 v23, s[40:43], s44 offen nt lds
    s_add_u32 m0, m0, 1024
    v_add_u32 v18, 4, v18
    v_max_i32 v19, v19, v18
    s_waitcnt vmcnt(40)
    ds_write_b32 v6, v19
    buffer_load_dwordx4 v24, s[40:43], s44 offen nt lds
    s_add_u32 m0, m0, 1024
    s_nop 0
    buffer_load_dwordx4 v25, s[40:43], s44 offen nt lds
    s_add_u32 m0, m0, 1024
    s_nop 0
    buffer_load_dwordx4 v26, s[40:43], s44 offen nt lds
    s_add_u32 m0, m0, 1024
    s_nop 0
    buffer_load_dwordx4 v27, s[40:43], s44 offen nt lds
    s_add_u32 m0, m0, 1024
    s_add_u32 s44, s44, 16384
    v_add_u32 v18, 4, v18
    v_max_i32 v19, v19, v18
    s_waitcnt vmcnt(40)
    ds_write_b32 v6, v19
    s_sub_u32 s45, s45, 1
    s_cmp_lg_u32 s45, 0
    s_cbranch_scc1 L_ld_31
    v_add_u32 v18, 4, v18
    v_max_i32 v19, v19, v18
    s_waitcnt vmcnt(36)
    ds_write_b32 v6, v19
    v_add_u32 v18, 4, v18
    v_max_i32 v19, v19, v18
    s_waitcnt vmcnt(32)
    ds_write_b32 v6, v19
    v_add_u32 v18, 4, v18
    v_max_i32 v19, v19, v18
    s_waitcnt vmcnt(28)
    ds_write_b32 v6, v19
    v_add_u32 v18, 4, v18
    v_max_i32 v19, v19, v18
    s_waitcnt vmcnt(24)
    ds_write_b32 v6, v19
    v_add_u32 v18, 4, v18
    v_max_i32 v19, v19, v18
    s_waitcnt vmcnt(20)
    ds_write_b32 v6, v19
    v_add_u32 v18, 4, v18
    v_max_i32 v19, v19, v18
    s_waitcnt vmcnt(16)
    ds_write_b32 v6, v19
    v_add_u32 v18, 4, v18
    v_max_i32 v19, v19, v18
    s_waitcnt vmcnt(12)
    ds_write_b32 v6, v19
    v_add_u32 v18, 4, v18
    v_max_i32 v19, v19, v18
    s_waitcnt vmcnt(8)
    ds_write_b32 v6, v19
    v_add_u32 v18, 4, v18
    v_max_i32 v19, v19, v18
    s_waitcnt vmcnt(4)
    ds_write_b32 v6, v19
    v_add_u32 v18, 4, v18
    v_max_i32 v19, v19, v18
    s_waitcnt vmcnt(0)
    ds_write_b32 v6, v19
    s_cmp_lt_u32 s46, 56
    s_cbranch_scc0 L_ld2_done
    s_mov_b32 s40, s22
    s_mov_b32 s41, s23
    s_mov_b32 s42, 1605632
    s_lshr_b32 s51, s46, 1
    s_and_b32 s53, s46, 1
    s_mul_i32 s44, s51, 57344
    s_mul_i32 s52, s53, 7168
    s_add_u32 s44, s44, s52
    s_mov_b32 m0, 0
L_wf_32:
    ds_read_b32 v8, v14 offset:0
    s_sub_u32 s50, s50, 1
    s_cbranch_scc1 L_end
    s_sleep 1
    s_waitcnt lgkmcnt(0)
    v_cmp_gt_i32 vcc, 3, v8
    s_cbranch_vccnz L_wf_32
    v_xor_b32 v16, 0, v7
    v_add_u32 v17, 4096, v16
    buffer_load_dwordx4 v16, s[40:43], s44 offen nt lds
    buffer_load_dwordx4 v16, s[40:43], s44 offen offset:1024 nt lds
    buffer_load_dwordx4 v16, s[40:43], s44 offen offset:2048 nt lds
    buffer_load_dwordx4 v16, s[40:43], s44 offen offset:3072 nt lds
    s_add_u32 m0, m0, 4096
    s_nop 0
    buffer_load_dwordx4 v17, s[40:43], s44 offen nt lds
    buffer_load_dwordx4 v17, s[40:43], s44 offen offset:1024 nt lds
    buffer_load_dwordx4 v17, s[40:43], s44 offen offset:2048 nt lds
    s_add_u32 m0, m0, 3072
    s_add_u32 s44, s44, 14336
    v_xor_b32 v16, 32, v7
    v_add_u32 v17, 4096, v16
    buffer_load_dwordx4 v16, s[40:43], s44 offen nt lds
    buffer_load_dwordx4 v16, s[40:43], s44 offen offset:1024 nt lds
    buffer_load_dwordx4 v16, s[40:43], s44 offen offset:2048 nt lds
    buffer_load_dwordx4 v16, s[40:43], s44 offen offset:3072 nt lds
    s_add_u32 m0, m0, 4096
    s_nop 0
    buffer_load_dwordx4 v17, s[40:43], s44 offen nt lds
    buffer_load_dwordx4 v17, s[40:43], s44 offen offset:1024 nt lds
    buffer_load_dwordx4 v17, s[40:43], s44 offen offset:2048 nt lds
    s_add_u32 m0, m0, 3072
    s_add_u32 s44, s44, 14336
    v_xor_b32 v16, 64, v7
    v_add_u32 v17, 4096, v16
    buffer_load_dwordx4 v16, s[40:43], s44 offen nt lds
    buffer_load_dwordx4 v16, s[40:43], s44 offen offset:1024 nt lds
    buffer_load_dwordx4 v16, s[40:43], s44 offen offset:2048 nt lds
    buffer_load_dwordx4 v16, s[40:43], s44 offen offset:3072 nt lds
    s_add_u32 m0, m0, 4096
    s_nop 0
    buffer_load_dwordx4 v17, s[40:43], s44 offen nt lds
    buffer_load_dwordx4 v17, s[40:43], s44 offen offset:1024 nt lds
    buffer_load_dwordx4 v17, s[40:43], s44 offen offset:2048 nt lds
    s_add_u32 m0, m0, 3072
    s_add_u32 s44, s44, 14336
    v_xor_b32 v16, 96, v7
    v_add_u32 v17, 4096, v16
    buffer_load_dwordx4 v16, s[40:43], s44 offen nt lds
    buffer_load_dwordx4 v16, s[40:43], s44 offen offset:1024 nt lds
    buffer_load_dwordx4 v16, s[40:43], s44 offen offset:2048 nt lds
    buffer_load_dwordx4 v16, s[40:43], s44 offen offset:3072 nt lds
    s_add_u32 m0, m0, 4096
    s_nop 0
    buffer_load_dwordx4 v17, s[40:43], s44 offen nt lds
    buffer_load_dwordx4 v17, s[40:43], s44 offen offset:1024 nt lds
    buffer_load_dwordx4 v17, s[40:43], s44 offen offset:2048 nt lds
    s_add_u32 m0, m0, 3072
    s_add_u32 s44, s44, 14336
    v_add_u32 v18, 28, v18
    v_max_i32 v19, v19, v18
    s_waitcnt vmcnt(0)
    ds_write_b32 v6, v19
L_ld2_done:
    s_endpgm
L_loader1b:
    v_add_u32 v18, 4, v18
    v_max_i32 v19, v19, v18
    s_waitcnt vmcnt(36)
    ds_write_b32 v6, v19
    v_add_u32 v18, 4, v18
    v_max_i32 v19, v19, v18
    s_waitcnt vmcnt(32)
    ds_write_b32 v6, v19
    v_add_u32 v18, 4, v18
    v_max_i32 v19, v19, v18
    s_waitcnt vmcnt(28)
    ds_write_b32 v6, v19
    v_add_u32 v18, 4, v18
    v_max_i32 v19, v19, v18
    s_waitcnt vmcnt(24)
    ds_write_b32 v6, v19
    v_add_u32 v18, 4, v18
    v_max_i32 v19, v19, v18
    s_waitcnt vmcnt(20)
    ds_write_b32 v6, v19
    v_add_u32 v18, 4, v18
    v_max_i32 v19, v19, v18
    s_waitcnt vmcnt(16)
    ds_write_b32 v6, v19
    v_add_u32 v18, 4, v18
    v_max_i32 v19, v19, v18
    s_waitcnt vmcnt(12)
    ds_write_b32 v6, v19
    v_add_u32 v18, 4, v18
    v_max_i32 v19, v19, v18
    s_waitcnt vmcnt(8)
    ds_write_b32 v6, v19
    v_add_u32 v18, 4, v18
    v_max_i32 v19, v19, v18
    s_waitcnt vmcnt(4)
    ds_write_b32 v6, v19
    v_add_u32 v18, 4, v18
    v_max_i32 v19, v19, v18
    s_waitcnt vmcnt(0)
    ds_write_b32 v6, v19
    v_and_b32 v8, 15, v1
    v_lshlrev_b32 v9, 1, v3
    v_xor_b32 v8, v8, v9
    v_lshlrev_b32 v8, 4, v8
    v_mul_u32_u24 v9, 3584, v3
    v_add_u32 v16, v8, v9
    v_xor_b32 v8, 128, v8
    v_add_u32 v17, v8, v9
    s_waitcnt lgkmcnt(0)
    s_add_u32 s58, s55, 1
    s_lshl_b32 s51, s31, 7
    s_add_u32 s51, s51, 65536
    v_and_b32 v37, 7, v1
    v_lshl_add_u32 v37, v37, 18, s51
L_wf_33:
    ds_read_b32 v8, v14 offset:0
    s_sub_u32 s50, s50, 1
    s_cbranch_scc1 L_end
    s_sleep 1
    s_waitcnt lgkmcnt(0)
    v_cmp_gt_i32 vcc, 2, v8
    s_cbranch_vccnz L_wf_33
    s_mov_b64 exec, 0xff
L_sn_34:
    global_load_dword v13, v37, s[28:29] sc1
    s_sub_u32 s50, s50, 1
    s_cbranch_scc1 L_end
    s_waitcnt vmcnt(0)
    v_cmp_ne_u32 vcc, s58, v13
    s_cbranch_vccnz L_sn_34
    s_mov_b64 exec, -1
    v_subrev_u32 v18, 40, v18
    s_xor_b32 s47, s46, 64
    s_cmp_lt_u32 s47, 98
    s_cbranch_scc0 L_ld_nogu
    s_mul_i32 s51, s47, 9363
    s_lshr_b32 s51, s51, 16
    s_mul_i32 s53, s51, 7
    s_sub_u32 s53, s47, s53
    s_mul_i32 s53, s53, 229376
    s_lshl_b32 s51, s51, 8
    s_add_u32 s53, s53, s51
    s_mov_b32 m0, 94208
    s_mov_b32 s44, s53
    s_mov_b32 s40, s18
    s_mov_b32 s41, s19
    s_mov_b32 s42, 1605632
    s_mov_b32 s45, 4
L_ld_35:
    buffer_load_dwordx4 v16, s[40:43], s44 offen nt lds
    s_add_u32 m0, m0, 1024
    s_add_u32 s44, s44, 14336
    buffer_load_dwordx4 v17, s[40:43], s44 offen nt lds
    s_add_u32 m0, m0, 1024
    s_add_u32 s44, s44, 14336
    buffer_load_dwordx4 v16, s[40:43], s44 offen nt lds
    s_add_u32 m0, m0, 1024
    s_add_u32 s44, s44, 14336
    buffer_load_dwordx4 v17, s[40:43], s44 offen nt lds
    s_add_u32 m0, m0, 1024
    s_add_u32 s44, s44, 14336
    v_add_u32 v18, 4, v18
    v_max_i32 v19, v19, v18
    s_waitcnt vmcnt(40)
    ds_write_b32 v6, v19
    s_sub_u32 s45, s45, 1
    s_cmp_lg_u32 s45, 0
    s_cbranch_scc1 L_ld_35
    s_mov_b32 s44, s53
    s_mov_b32 s40, s20
    s_mov_b32 s41, s21
    s_mov_b32 s42, 1605632
    s_mov_b32 s45, 4
L_ld_36:
    buffer_load_dwordx4 v16, s[40:43], s44 offen nt lds
    s_add_u32 m0, m0, 1024
    s_add_u32 s44, s44, 14336
    buffer_load_dwordx4 v17, s[40:43], s44 offen nt lds
    s_add_u32 m0, m0, 1024
    s_add_u32 s44, s44, 14336
    buffer_load_dwordx4 v16, s[40:43], s44 offen nt lds
    s_add_u32 m0, m0, 1024
    s_add_u32 s44, s44, 14336
    buffer_load_dwordx4 v17, s[40:43], s44 offen nt lds
    s_add_u32 m0, m0, 1024
    s_add_u32 s44, s44, 14336
    v_add_u32 v18, 4, v18
    v_max_i32 v19, v19, v18
    s_waitcnt vmcnt(40)
    ds_write_b32 v6, v19
    s_sub_u32 s45, s45, 1
    s_cmp_lg_u32 s45, 0
    s_cbranch_scc1 L_ld_36
    s_branch L_ld_fdone
L_ld_nogu:
L_ld_fdone:
    s_mov_b32 s40, s12
    s_mov_b32 s41, s13
    s_mov_b32 s42, 8388608
    s_mov_b32 s44, s54
    s_mov_b32 m0, 0
    s_mov_b32 s53, 0
L_ld_uv:
    v_xor_b32 v16, s53, v20
    buffer_load_dwordx4 v16, s[40:43], s44 offen nt lds
    s_add_u32 m0, m0, 1024
    s_add_u32 s44, s44, 16384
    buffer_load_dwordx4 v16, s[40:43], s44 offen nt lds
    s_add_u32 m0, m0, 1024
    s_add_u32 s44, s44, 16384
    buffer_load_dwordx4 v16, s[40:43], s44 offen nt lds
    s_add_u32 m0, m0, 1024
    s_add_u32 s44, s44, 16384
    buffer_load_dwordx4 v16, s[40:43], s44 offen nt lds
    s_add_u32 m0, m0, 1024
    s_add_u32 s44, s44, 16384
    v_add_u32 v18, 4, v18
    v_max_i32 v19, v19, v18
    s_waitcnt vmcnt(40)
    ds_write_b32 v6, v19
    buffer_load_dwordx4 v16, s[40:43], s44 offen nt lds
    s_add_u32 m0, m0, 1024
    s_add_u32 s44, s44, 16384
    buffer_load_dwordx4 v16, s[40:43], s44 offen nt lds
    s_add_u32 m0, m0, 1024
    s_add_u32 s44, s44, 16384
    buffer_load_dwordx4 v16, s[40:43], s44 offen nt lds
    s_add_u32 m0, m0, 1024
    s_add_u32 s44, s44, 16384
    buffer_load_dwordx4 v16, s[40:43], s44 offen nt lds
    s_add_u32 m0, m0, 1024
    s_add_u32 s44, s44, 16384
    v_add_u32 v18, 4, v18
    v_max_i32 v19, v19, v18
    s_waitcnt vmcnt(40)
    ds_write_b32 v6, v19
    s_add_u32 s53, s53, 32
    s_cmp_lg_u32 s53, 256
    s_cbranch_scc1 L_ld_uv
    s_mov_b32 s40, s14
    s_mov_b32 s41, s15
    s_mov_b32 s42, 3670016
    s_bfe_u32 s51, s31, 0x20001
    s_and_b32 s53, s31, 1
    s_mul_i32 s44, s32, 229376
    s_mul_i32 s52, s51, 57344
    s_add_u32 s44, s44, s52
    s_mul_i32 s52, s53, 7168
    s_add_u32 s44, s44, s52
    s_mov_b32 m0, 65536
    v_add_u32 v18, 4, v18
    v_max_i32 v19, v19, v18
    s_waitcnt vmcnt(36)
    ds_write_b32 v6, v19
    v_add_u32 v18, 4, v18
    v_max_i32 v19, v19, v18
    s_waitcnt vmcnt(32)
    ds_write_b32 v6, v19
    v_add_u32 v18, 4, v18
    v_max_i32 v19, v19, v18
    s_waitcnt vmcnt(28)
    ds_write_b32 v6, v19
    v_add_u32 v18, 4, v18
    v_max_i32 v19, v19, v18
    s_waitcnt vmcnt(24)
    ds_write_b32 v6, v19
    v_add_u32 v18, 4, v18
    v_max_i32 v19, v19, v18
    s_waitcnt vmcnt(20)
    ds_write_b32 v6, v19
    v_add_u32 v18, 4, v18
    v_max_i32 v19, v19, v18
    s_waitcnt vmcnt(16)
    ds_write_b32 v6, v19
    v_add_u32 v18, 4, v18
    v_max_i32 v19, v19, v18
    s_waitcnt vmcnt(12)
    ds_write_b32 v6, v19
    v_add_u32 v18, 4, v18
    v_max_i32 v19, v19, v18
    s_waitcnt vmcnt(8)
    ds_write_b32 v6, v19
    v_add_u32 v18, 4, v18
    v_max_i32 v19, v19, v18
    s_waitcnt vmcnt(4)
    ds_write_b32 v6, v19
    v_add_u32 v18, 4, v18
    v_max_i32 v19, v19, v18
    s_waitcnt vmcnt(0)
    ds_write_b32 v6, v19
L_wf_38:
    ds_read_b32 v8, v14 offset:0
    s_sub_u32 s50, s50, 1
    s_cbranch_scc1 L_end
    s_sleep 1
    s_waitcnt lgkmcnt(0)
    v_cmp_gt_i32 vcc, 4, v8
    s_cbranch_vccnz L_wf_38
    v_subrev_u32 v18, 40, v18
    v_xor_b32 v16, 0, v7
    v_add_u32 v17, 4096, v16
    buffer_load_dwordx4 v16, s[40:43], s44 offen nt lds
    buffer_load_dwordx4 v16, s[40:43], s44 offen offset:1024 nt lds
    buffer_load_dwordx4 v16, s[40:43], s44 offen offset:2048 nt lds
    buffer_load_dwordx4 v16, s[40:43], s44 offen offset:3072 nt lds
    s_add_u32 m0, m0, 4096
    s_nop 0
    buffer_load_dwordx4 v17, s[40:43], s44 offen nt lds
    buffer_load_dwordx4 v17, s[40:43], s44 offen offset:1024 nt lds
    buffer_load_dwordx4 v17, s[40:43], s44 offen offset:2048 nt lds
    s_add_u32 m0, m0, 3072
    s_add_u32 s44, s44, 14336
    v_add_u32 v18, 7, v18
    v_max_i32 v19, v19, v18
    s_waitcnt vmcnt(40)
    ds_write_b32 v6, v19
    v_xor_b32 v16, 32, v7
    v_add_u32 v17, 4096, v16
    buffer_load_dwordx4 v16, s[40:43], s44 offen nt lds
    buffer_load_dwordx4 v16, s[40:43], s44 offen offset:1024 nt lds
    buffer_load_dwordx4 v16, s[40:43], s44 offen offset:2048 nt lds
    buffer_load_dwordx4 v16, s[40:43], s44 offen offset:3072 nt lds
    s_add_u32 m0, m0, 4096
    s_nop 0
    buffer_load_dwordx4 v17, s[40:43], s44 offen nt lds
    buffer_load_dwordx4 v17, s[40:43], s44 offen offset:1024 nt lds
    buffer_load_dwordx4 v17, s[40:43], s44 offen offset:2048 nt lds
    s_add_u32 m0, m0, 3072
    s_add_u32 s44, s44, 14336
    v_add_u32 v18, 7, v18
    v_max_i32 v19, v19, v18
    s_waitcnt vmcnt(40)
    ds_write_b32 v6, v19
    v_xor_b32 v16, 64, v7
    v_add_u32 v17, 4096, v16
    buffer_load_dwordx4 v16, s[40:43], s44 offen nt lds
    buffer_load_dwordx4 v16, s[40:43], s44 offen offset:1024 nt lds
    buffer_load_dwordx4 v16, s[40:43], s44 offen offset:2048 nt lds
    buffer_load_dwordx4 v16, s[40:43], s44 offen offset:3072 nt lds
    s_add_u32 m0, m0, 4096
    s_nop 0
    buffer_load_dwordx4 v17, s[40:43], s44 offen nt lds
    buffer_load_dwordx4 v17, s[40:43], s44 offen offset:1024 nt lds
    buffer_load_dwordx4 v17, s[40:43], s44 offen offset:2048 nt lds
    s_add_u32 m0, m0, 3072
    s_add_u32 s44, s44, 14336
    v_add_u32 v18, 7, v18
    v_max_i32 v19, v19, v18
    s_waitcnt vmcnt(40)
    ds_write_b32 v6, v19
    v_xor_b32 v16, 96, v7
    v_add_u32 v17, 4096, v16
    buffer_load_dwordx4 v16, s[40:43], s44 offen nt lds
    buffer_load_dwordx4 v16, s[40:43], s44 offen offset:1024 nt lds
    buffer_load_dwordx4 v16, s[40:43], s44 offen offset:2048 nt lds
    buffer_load_dwordx4 v16, s[40:43], s44 offen offset:3072 nt lds
    s_add_u32 m0, m0, 4096
    s_nop 0
    buffer_load_dwordx4 v17, s[40:43], s44 offen nt lds
    buffer_load_dwordx4 v17, s[40:43], s44 offen offset:1024 nt lds
    buffer_load_dwordx4 v17, s[40:43], s44 offen offset:2048 nt lds
    s_add_u32 m0, m0, 3072
    s_add_u32 s44, s44, 14336
    v_add_u32 v18, 7, v18
    v_max_i32 v19, v19, v18
    s_waitcnt vmcnt(40)
    ds_write_b32 v6, v19
    v_add_u32 v18, 40, v18
    v_max_i32 v19, v19, v18
    s_waitcnt vmcnt(0)
    ds_write_b32 v6, v19
    s_cmp_lt_u32 s46, 64
    s_cbranch_scc1 L_fdone
    s_setprio 0
    v_and_b32 v2, 15, v1
    v_lshrrev_b32 v26, 2, v1
    v_and_b32 v27, 3, v1
    v_lshlrev_b32 v27, 3, v27
    s_mov_b32 s39, 0xfff
    s_add_u32 s58, s55, 1
    s_and_b32 s38, s58, 0xfff
    v_mov_b32 v4, s38
    s_bfe_u32 s51, s46, 0x20004
    s_bfe_u32 s53, s46, 0x10003
    s_bfe_u32 s54, s46, 0x10002
    s_mul_i32 s45, s51, 224
    s_lshl_b32 s52, s53, 7
    s_add_u32 s45, s45, s52
    s_mul_i32 s52, s54, 896
    s_add_u32 s45, s45, s52
    s_and_b32 s51, s46, 3
    s_lshl_b32 s51, s51, 3
    s_add_u32 s45, s45, s51
    v_lshlrev_b32 v92, 2, v27
    v_and_b32 v9, 3, v26
    v_lshl_add_u32 v92, v9, 1, v92
    v_add_u32 v92, s45, v92
    v_min_u32 v93, 1790, v92
    global_load_ushort v94, v93, s[4:5]
    s_lshl_b32 s51, s30, 18
    s_lshl_b32 s52, s31, 12
    s_add_u32 s51, s51, s52
    s_add_u32 s51, s51, 63488
    v_add_u32 v80, s51, v7
    v_add_u32 v81, 152960, v7
    v_lshlrev_b32 v82, 2, v2
    v_add_u32 v82, 152704, v82
    s_cmp_eq_u32 s53, 0
    s_cselect_b32 s54, -1, 0x7777
    s_and_b32 s54, s54, 0xffff
L_wf_39:
    ds_read_b32 v8, v6 offset:16
    s_sub_u32 s50, s50, 1
    s_cbranch_scc1 L_end
    s_waitcnt lgkmcnt(0)
    v_cmp_gt_i32 vcc, 7, v8
    s_cbranch_vccnz L_wf_39
L_hf2_40_f:
    v_mov_b32 v44, v4
    v_mov_b32 v45, v4
    v_mov_b32 v46, v4
    v_mov_b32 v47, v4
    global_load_dwordx4 v[32:35], v80, s[28:29] offset:0 sc1
    global_load_dwordx4 v[36:39], v80, s[28:29] offset:1024 sc1
    global_load_dwordx4 v[40:43], v80, s[28:29] offset:2048 sc1
    s_mov_b32 exec_lo, 0xffffffff
    s_mov_b32 exec_hi, 0x0
    global_load_dwordx4 v[44:47], v80, s[28:29] offset:3072 sc1
    s_mov_b64 exec, -1
    s_waitcnt vmcnt(0)
    v_xor_b32 v32, v32, v4
    v_xor_b32 v33, v33, v4
    v_xor_b32 v34, v34, v4
    v_xor_b32 v35, v35, v4
    v_xor_b32 v36, v36, v4
    v_xor_b32 v37, v37, v4
    v_xor_b32 v38, v38, v4
    v_xor_b32 v39, v39, v4
    v_xor_b32 v40, v40, v4
    v_xor_b32 v41, v41, v4
    v_xor_b32 v42, v42, v4
    v_xor_b32 v43, v43, v4
    v_xor_b32 v44, v44, v4
    v_xor_b32 v45, v45, v4
    v_xor_b32 v46, v46, v4
    v_xor_b32 v47, v47, v4
    v_or3_b32 v48, v32, v33, v34
    v_or3_b32 v48, v48, v35, v36
    v_or3_b32 v48, v48, v37, v38
    v_or3_b32 v48, v48, v39, v40
    v_or3_b32 v48, v48, v41, v42
    v_or3_b32 v48, v48, v43, v44
    v_or3_b32 v48, v48, v45, v46
    v_or_b32 v48, v48, v47
    v_and_b32 v48, s39, v48
    v_cmp_ne_u32 vcc, 0, v48
    s_cbranch_vccnz L_hf2_40
    v_pk_add_f32 v[32:33], v[32:33], v[36:37]
    v_pk_add_f32 v[40:41], v[40:41], v[44:45]
    v_pk_add_f32 v[34:35], v[34:35], v[38:39]
    v_pk_add_f32 v[42:43], v[42:43], v[46:47]
    v_pk_add_f32 v[32:33], v[32:33], v[40:41]
    v_pk_add_f32 v[34:35], v[34:35], v[42:43]
    s_nop 0
    v_add_f32_dpp v32, v32, v32 row_ror:4 row_mask:0xf bank_mask:0xf
    v_add_f32_dpp v33, v33, v33 row_ror:4 row_mask:0xf bank_mask:0xf
    v_add_f32_dpp v34, v34, v34 row_ror:4 row_mask:0xf bank_mask:0xf
    v_add_f32_dpp v35, v35, v35 row_ror:4 row_mask:0xf bank_mask:0xf
    v_add_f32_dpp v32, v32, v32 row_ror:8 row_mask:0xf bank_mask:0xf
    v_add_f32_dpp v33, v33, v33 row_ror:8 row_mask:0xf bank_mask:0xf
    v_add_f32_dpp v34, v34, v34 row_ror:8 row_mask:0xf bank_mask:0xf
    v_add_f32_dpp v35, v35, v35 row_ror:8 row_mask:0xf bank_mask:0xf
    v_mov_b32 v36, v32
    v_mov_b32 v37, v33
    v_mov_b32 v38, v34
    v_mov_b32 v39, v35
    v_permlane16_swap_b32 v32, v36
    v_permlane16_swap_b32 v33, v37
    v_permlane16_swap_b32 v34, v38
    v_permlane16_swap_b32 v35, v39
    v_add_f32 v32, v32, v36
    v_add_f32 v33, v33, v37
    v_add_f32 v34, v34, v38
    v_add_f32 v35, v35, v39
    v_mov_b32 v36, v32
    v_mov_b32 v37, v33
    v_mov_b32 v38, v34
    v_mov_b32 v39, v35
    v_permlane32_swap_b32 v32, v36
    v_permlane32_swap_b32 v33, v37
    v_permlane32_swap_b32 v34, v38
    v_permlane32_swap_b32 v35, v39
    v_add_f32 v32, v32, v36
    v_add_f32 v33, v33, v37
    v_add_f32 v34, v34, v38
    v_add_f32 v35, v35, v39
    s_mov_b64 exec, 15
    ds_write_b128 v81, v[32:35]
    s_mov_b64 exec, -1
    ds_read_b32 v40, v82 offset:256
    s_waitcnt lgkmcnt(0)
    v_cvt_pk_bf16_f32 v40, v40, v40
    v_and_b32 v40, 0xffff0000, v40
    v_mul_f32 v41, 0xbfb8aa3b, v40
    v_exp_f32 v41, v41
    s_nop 0
    v_add_f32 v41, 1.0, v41
    v_rcp_f32 v41, v41
    s_nop 0
    v_mul_f32 v40, v40, v41
    v_cvt_pk_bf16_f32 v40, v40, v40
    v_and_b32 v40, 0xffff0000, v40
    v_lshlrev_b32 v94, 16, v94
L_wf_41:
    ds_read_b32 v8, v14 offset:0
    ds_read_b32 v32, v82 offset:0
    ds_read_b32 v33, v82 offset:64
    ds_read_b32 v34, v82 offset:128
    ds_read_b32 v35, v82 offset:192
    s_sub_u32 s50, s50, 1
    s_cbranch_scc1 L_end
    s_waitcnt lgkmcnt(4)
    v_cmp_gt_i32 vcc, 8, v8
    s_cbranch_vccnz L_wf_41
    s_waitcnt lgkmcnt(0)
    v_add_f32 v32, v32, v33
    v_add_f32 v34, v34, v35
    v_add_f32 v32, v32, v34
    v_cvt_pk_bf16_f32 v32, v32, v32
    v_and_b32 v32, 0xffff0000, v32
    v_mul_f32 v32, v32, v40
    v_cvt_pk_bf16_f32 v32, v32, v32
    v_and_b32 v32, 0xffff0000, v32
    v_add_f32 v32, v32, v94
    v_cvt_pk_bf16_f32 v32, v32, v32
    s_mov_b32 exec_lo, s54
    s_mov_b32 exec_hi, 0
    global_store_short v92, v32, s[24:25]
    s_cmp_lg_u32 s46, 64
    s_cbranch_scc1 L_fdone
    v_mov_b32 v33, s58
    v_mov_b32 v34, 0
    s_mov_b64 exec, 1
    global_store_dword v34, v33, s[28:29] sc1
L_fdone:
    s_endpgm
L_hf2_40:
    s_sub_u32 s50, s50, 1
    s_cbranch_scc1 L_end
    s_sleep 2
    s_branch L_hf2_40_f
L_end:
    s_endpgm
L_codeend:
.section .rodata,"a"
.p2align 6
.amdhsa_kernel recurrent_scan__compressed_kv_cla__geglu_ffn__decode_kernel
  .amdhsa_next_free_vgpr 256
  .amdhsa_next_free_sgpr 102
  .amdhsa_accum_offset 256
  .amdhsa_group_segment_fixed_size 0
  .amdhsa_kernarg_size 104
  .amdhsa_user_sgpr_count 2
  .amdhsa_user_sgpr_kernarg_segment_ptr 1
  .amdhsa_system_sgpr_workgroup_id_x 1
.end_amdhsa_kernel
```
